```python
import torch

def _softmax(x, axis=-1):
    return torch.softmax(x, dim=axis)
def _gelu(x):
    return torch.nn.functional.gelu(x, approximate="tanh")
def _silu(x):
    return torch.nn.functional.silu(x)
def _sigmoid(x):
    return torch.sigmoid(x)
def _layernorm(x, axis=-1, eps=1e-5):
    m = x.mean(dim=axis, keepdim=True)
    v = x.var(dim=axis, keepdim=True, unbiased=False)
    return (x - m) / torch.sqrt(v + eps)
def _scatter_add(tgt, idx, src, axis=0):
    return tgt.clone().index_add_(axis, idx, src)
def _segment_sum(src, seg, n):
    out = torch.zeros((n,) + src.shape[1:], dtype=src.dtype)
    return out.index_add_(0, seg, src)
def _pad(x, pw):
    flat = tuple(v for pair in reversed(pw) for v in pair)
    return torch.nn.functional.pad(x, flat)

kernel_name = 'gated_mix__softmax_full_mha__linear_kernel_hedgehog__prompt'

def setup_inputs():

    _w = (lambda a: (lambda t: t.to(torch.bfloat16) if t.is_floating_point() else t)(torch.as_tensor(a)))
    def _A_setup():
        B, S, D = 1, 2048, 512
        return {
            "x": _w((lambda *s: torch.randn(*s, dtype=torch.bfloat16) * 0.05)(B, S, D)),
            "wqkv": _w((lambda *s: torch.randn(*s, dtype=torch.bfloat16) * 0.8)(D, 3 * D)),
            "wo": _w((lambda *s: torch.randn(*s, dtype=torch.bfloat16) * 0.05)(D, D)),
        }
    _A_in = _A_setup()

    def _B_setup():
        B, S, D, H = 1, 2048, 512, 32
        Dh = D // H
        return {
            "x": _w((lambda *s: torch.randn(*s, dtype=torch.bfloat16) * 0.05)(B, S, D)),
            "wqkv": _w((lambda *s: torch.randn(*s, dtype=torch.bfloat16) * 1.6)(D, 3 * D)),
            "w_phi": _w((lambda *s: torch.randn(*s, dtype=torch.bfloat16) * 1.6)(H, Dh, Dh) * (Dh ** -0.5)),
            "wo": _w((lambda *s: torch.randn(*s, dtype=torch.bfloat16) * 0.05)(D, D)),
        }
    _B_in = _B_setup()

    return {
        "A_x": _A_in["x"],
        "A_wqkv": _A_in["wqkv"],
        "A_wo": _A_in["wo"],
        "B_x": _B_in["x"],
        "B_wqkv": _B_in["wqkv"],
        "B_w_phi": _B_in["w_phi"],
        "B_wo": _B_in["wo"],
        "gate_w": _w((lambda *s: torch.randn(*s, dtype=torch.bfloat16) * 0.05)(512) * 16.0),
    }

def reference(A_x, A_wqkv, A_wo, B_x, B_wqkv, B_w_phi, B_wo, gate_w):
    def _A_ref(x, wqkv, wo):
        B, S, D = x.shape
        H = 32; Dh = D // H
        qkv = (lambda x, *d: x.permute(*d))((x @ wqkv).reshape(B, S, 3, H, Dh), 2, 0, 3, 1, 4)
        q, k, v = qkv[0], qkv[1], qkv[2]
        scale = Dh ** -0.5
        scores = torch.einsum("bhqd,bhkd->bhqk", q, k) * scale
        p = _softmax(scores, axis=-1)
        o = torch.einsum("bhqk,bhkd->bhqd", p, v)
        return (lambda x, *d: x.permute(*d))(o, 0, 2, 1, 3).reshape(B, S, D) @ wo

    def _B_ref(x, wqkv, w_phi, wo):
        B, S, D = x.shape
        H = 32; Dh = D // H
        qkv = (lambda x, *d: x.permute(*d))((x @ wqkv).reshape(B, S, 3, H, Dh), 2, 0, 3, 1, 4)
        q, k, v = qkv[0], qkv[1], qkv[2]
        pq = torch.einsum("bhsd,hdf->bhsf", q, w_phi)
        pk = torch.einsum("bhsd,hdf->bhsf", k, w_phi)
        phi_q = torch.concatenate([_softmax(pq, axis=-1), _softmax(-pq, axis=-1)], axis=-1)
        phi_k = torch.concatenate([_softmax(pk, axis=-1), _softmax(-pk, axis=-1)], axis=-1)
        kv = torch.einsum("bhsf,bhsd->bhfd", phi_k, v)
        z  = torch.einsum("bhsf->bhf", phi_k)
        num = torch.einsum("bhqf,bhfd->bhqd", phi_q, kv)
        den = torch.einsum("bhqf,bhf->bhq", phi_q, z)[..., None] + 1e-6
        o = num / den
        return (lambda x, *d: x.permute(*d))(o, 0, 2, 1, 3).reshape(B, S, D) @ wo

    x = A_x
    g = _sigmoid((x * gate_w).sum(-1, keepdims=True))
    a = _A_ref(x, A_wqkv, A_wo)
    b = _B_ref(x, B_wqkv, B_w_phi, B_wo)
    return g * a + (1 - g) * b
```

```asm
; @launch grid=(256,1,1) block=(512,1,1) lds=163840
.amdgcn_target "amdgcn-amd-amdhsa--gfx950"
.text
.globl gated_mix__softmax_full_mha__linear_kernel_hedgehog__prompt_kernel
.p2align 8
.type gated_mix__softmax_full_mha__linear_kernel_hedgehog__prompt_kernel,@function
gated_mix__softmax_full_mha__linear_kernel_hedgehog__prompt_kernel:
    s_cmp_ge_u32 s2, 256
    s_cbranch_scc1 L_end
    s_load_dwordx16 s[64:79], s[0:1], 0
    s_load_dwordx4 s[80:83], s[0:1], 64
    s_load_dwordx2 s[84:85], s[0:1], 80
    s_getpc_b64 s[86:87]
    s_lshr_b32 s35, s2, 3
    s_and_b32 s35, s35, 3
    s_mul_i32 s35, s35, 9216
    v_and_b32 v61, 63, v0
    v_lshrrev_b32 v62, 6, v0
    v_min_u32 v61, 8, v61
    v_mad_u32_u24 v62, v62, 9, v61
    v_lshlrev_b32 v62, 7, v62
    v_add_u32 v62, s35, v62
    v_min_u32 v62, 34528, v62
    global_load_dword v63, v62, s[86:87]
    v_and_b32 v1, 63, v0
    v_lshrrev_b32 v2, 6, v0
    s_and_b32 s36, s2, 7
    s_lshr_b32 s37, s2, 3
    v_readfirstlane_b32 s31, v2
    s_and_b32 s41, s37, 3
    s_lshr_b32 s40, s37, 2
    s_lshr_b32 s28, s36, 1
    s_lshl_b32 s28, s28, 2
    s_add_u32 s28, s28, s41
    s_and_b32 s30, s36, 1
    s_lshl_b32 s35, s40, 1
    s_add_u32 s30, s30, s35
    s_mul_i32 s43, s41, 0
    s_mul_i32 s35, s40, 2
    s_add_u32 s43, s43, s35
    s_and_b32 s43, s43, 7
    v_lshrrev_b32 v11, 3, v1
    v_and_b32 v12, 7, v1
    v_lshrrev_b32 v13, 4, v1
    v_xor_b32 v15, v12, v13
    v_mul_u32_u24 v4, 3072, v11
    v_lshlrev_b32 v11, 10, v11
    v_lshl_add_u32 v2, v15, 4, v11
    v_xor_b32 v3, 64, v2
    v_add_u32 v3, 7168, v3
    s_and_b32 s35, s31, 1
    s_lshl_b32 s35, s35, 6
    v_and_b32 v15, 16, v1
    v_lshlrev_b32 v15, 1, v15
    v_lshlrev_b32 v12, 4, v12
    v_xor_b32 v15, v15, v12
    v_xor_b32 v15, s35, v15
    v_add_u32 v4, v4, v15
    s_lshl_b32 s38, s30, 3
    s_add_u32 s38, s38, s31
    s_lshl_b32 s38, s38, 14
    s_mul_i32 s42, s31, 24576
    s_lshr_b32 s44, s28, 1
    s_lshl_b32 s35, s44, 7
    s_add_u32 s42, s42, s35
    s_lshl_b32 s46, s31, 11
    s_lshl_b32 s47, s31, 10
    s_mov_b32 s10, 0x200000
    s_mov_b32 s11, 0x20000
    s_mov_b32 s14, 0x180000
    s_mov_b32 s15, 0x20000
    s_lshl_b32 s34, s43, 7
    s_add_u32 s34, s34, s38
    s_mul_i32 s37, s43, 196608
    s_add_u32 s37, s37, s42
    s_mov_b32 m0, s46
    s_waitcnt lgkmcnt(0)
    s_mov_b32 s8, s64
    s_mov_b32 s9, s65
    buffer_load_dwordx4 v2, s[8:11], s34 offen lds
    s_mov_b32 s12, s66
    s_mov_b32 s13, s67
    s_bitcmp1_b32 s41, 0
    buffer_load_dwordx4 v3, s[8:11], s34 offen offset:1024 lds
    s_cbranch_scc1 L_ty1
    s_add_u32 m0, s46, 64512
    s_nop 0
    buffer_load_dwordx4 v4, s[12:15], s37 offen offset:1024 lds
    buffer_load_dwordx4 v4, s[12:15], s37 offen offset:2048 lds
    s_cmp_lg_u32 s2, 128
    s_cbranch_scc1 L_noz
    s_mov_b32 s20, s84
    s_mov_b32 s21, s85
    s_mov_b32 s22, 0x1300000
    s_mov_b32 s23, 0x20000
    v_lshlrev_b32 v12, 7, v1
    s_add_u32 s35, s47, 17825792
    v_mov_b32 v16, 0
    v_mov_b32 v17, 0
    v_mov_b32 v18, 0
    v_mov_b32 v19, 0
    s_mov_b64 exec, 0xff
    buffer_store_dwordx4 v[16:19], v12, s[20:23], s35 offen sc1
    s_mov_b64 exec, -1
L_noz:
    s_add_u32 s35, s43, 1
    s_and_b32 s35, s35, 7
    s_lshl_b32 s64, s35, 7
    s_add_u32 s64, s64, s38
    s_mul_i32 s65, s35, 196608
    s_add_u32 s65, s65, s42
    s_barrier
    s_add_u32 m0, s46, 16384
    s_nop 0
    buffer_load_dwordx4 v2, s[8:11], s64 offen lds
    buffer_load_dwordx4 v3, s[8:11], s64 offen offset:1024 lds
    s_and_b32 s32, s31, 3
    s_lshr_b32 s33, s31, 2
    s_mov_b32 s24, s74
    s_mov_b32 s25, s75
    s_mov_b32 s26, 0x4000
    s_mov_b32 s27, 0x20000
    s_mov_b32 s88, s78
    s_mov_b32 s89, s79
    s_mov_b32 s90, 0x400
    s_mov_b32 s91, 0x20000
    v_lshlrev_b32 v0, 4, v1
    s_lshl_b32 s44, s44, 1
    s_add_u32 s44, s44, s33
    s_lshl_b32 s56, s44, 10
    s_lshl_b32 s96, s30, 4
    s_add_u32 s96, s96, s28
    s_lshl_b32 s96, s96, 3
    s_add_u32 s96, s96, s31
    s_lshl_b32 s57, s96, 10
    s_add_u32 s35, s43, 2
    s_and_b32 s35, s35, 7
    s_lshl_b32 s66, s35, 7
    s_add_u32 s66, s66, s38
    s_mul_i32 s67, s35, 196608
    s_add_u32 s67, s67, s42
    s_mov_b32 s20, s84
    s_mov_b32 s21, s85
    s_mov_b32 s22, 0x1300000
    s_mov_b32 s23, 0x20000
    s_mov_b32 s16, s72
    s_mov_b32 s17, s73
    s_mov_b32 s18, 0x180000
    s_mov_b32 s19, 0x20000
    s_add_u32 s35, s43, 3
    s_and_b32 s35, s35, 7
    s_lshl_b32 s70, s35, 7
    s_add_u32 s70, s70, s38
    s_mul_i32 s71, s35, 196608
    s_add_u32 s71, s71, s42
    v_and_b32 v12, 15, v1
    v_lshlrev_b32 v5, 7, v12
    v_lshrrev_b32 v15, 1, v12
    v_xor_b32 v15, v15, v13
    v_lshl_add_u32 v5, v15, 4, v5
    s_lshl_b32 s35, s32, 12
    v_add_u32 v5, s35, v5
    v_xor_b32 v6, 64, v5
    v_and_b32 v15, 24, v1
    s_lshl_b32 s35, s33, 4
    v_xor_b32 v15, s35, v15
    v_and_b32 v9, 12, v1
    v_lshlrev_b32 v9, 5, v9
    v_lshl_add_u32 v9, v15, 2, v9
    v_and_b32 v15, 3, v1
    v_lshl_add_u32 v9, v15, 3, v9
    v_lshl_add_u32 v9, v13, 11, v9
    v_add_u32 v7, 0x10000, v9
    v_xor_b32 v8, 32, v7
    v_add_u32 v9, 0x20000, v9
    v_xor_b32 v11, 32, v9
    s_lshl_b32 s51, s30, 2
    s_add_u32 s51, s51, s32
    s_lshl_b32 s52, s44, 7
    s_add_u32 s52, s52, s51
    s_lshl_b32 s53, s52, 10
    s_lshl_b32 s39, s36, 2
    s_add_u32 s39, s39, s41
    s_lshl_b32 s45, s40, 3
    s_lshl_b32 s92, s32, 1
    s_add_u32 s62, s45, s92
    s_add_u32 s62, s62, s33
    s_add_u32 s45, s45, s31
    s_lshl_b32 s97, s62, 6
    s_add_u32 s97, s97, s39
    s_lshl_b32 s97, s97, 10
    s_add_u32 s97, s97, 13631488
    s_mov_b32 s4, s82
    s_mov_b32 s5, s83
    s_mov_b32 s6, 0x100
    s_mov_b32 s7, 0x20000
    s_add_u32 s35, s43, 4
    s_and_b32 s35, s35, 7
    s_lshl_b32 s72, s35, 7
    s_add_u32 s72, s72, s38
    s_mul_i32 s73, s35, 196608
    s_add_u32 s73, s73, s42
    s_add_u32 s35, s43, 5
    s_and_b32 s35, s35, 7
    s_lshl_b32 s74, s35, 7
    s_add_u32 s74, s74, s38
    s_mul_i32 s75, s35, 196608
    s_add_u32 s75, s75, s42
    s_add_u32 s35, s43, 6
    s_and_b32 s35, s35, 7
    s_lshl_b32 s78, s35, 7
    s_add_u32 s78, s78, s38
    s_mul_i32 s79, s35, 196608
    s_add_u32 s79, s79, s42
    s_mov_b32 s34, s2
    s_bitcmp1_b32 s36, 0
    s_cselect_b32 s0, s76, s68
    s_cselect_b32 s1, s77, s69
    s_mov_b32 s2, 0x80000
    s_mov_b32 s3, 0x20000
    s_add_u32 s35, s43, 7
    s_and_b32 s35, s35, 7
    s_lshl_b32 s68, s35, 7
    s_add_u32 s68, s68, s38
    s_mul_i32 s69, s35, 196608
    s_add_u32 s69, s69, s42
    s_mov_b32 s42, s34
    s_lshr_b32 s96, s96, 3
    s_lshl_b32 s96, s96, 7
    s_add_u32 s96, s96, 12582912
    v_mov_b32 v96, 0
    v_mov_b32 v97, 0
    v_mov_b32 v100, 0
    v_mov_b32 v101, 0
    v_mov_b32 v104, 0
    s_add_u32 m0, s46, 80896
    s_nop 0
    buffer_load_dwordx4 v4, s[12:15], s65 offen offset:1024 lds
    v_mov_b32 v105, 0
    v_and_b32 v13, 1, v1
    v_lshrrev_b32 v15, 5, v1
    v_cmp_eq_u32 s[58:59], v13, v15
    v_mov_b32 v13, 0x3f803f80
    s_nop 0
    buffer_load_dwordx4 v4, s[12:15], s65 offen offset:2048 lds
    v_cndmask_b32 v106, 0, v13, s[58:59]
    v_cndmask_b32 v107, 0, v13, s[58:59]
    v_cndmask_b32 v108, 0, v13, s[58:59]
    v_cndmask_b32 v109, 0, v13, s[58:59]
    v_lshrrev_b32 v13, 2, v1
    v_lshlrev_b32 v13, 10, v13
    buffer_load_dwordx4 v[252:255], v0, s[88:91], 0 offen
    v_and_b32 v15, 3, v1
    v_lshl_add_u32 v122, v15, 4, v13
    v_and_b32 v13, 0x1c, v1
    v_and_b32 v12, 16, v1
    v_add_u32 v13, v13, v12
    v_lshlrev_b32 v15, 3, v15
    buffer_load_dwordx4 v[248:251], v0, s[8:11], s57 offen
    v_lshl_add_u32 v13, v13, 4, v15
    v_and_b32 v15, 32, v1
    s_add_u32 s92, s47, 55296
    v_add3_u32 v125, v13, v15, s92
    v_and_b32 v13, 0x1f0, v0
    v_lshl_add_u32 v126, v15, 9, v13
    buffer_load_dwordx4 v[240:243], v0, s[24:27], s56 offen
    v_mov_b32 v10, 0xdddddddd
    s_lshl_b32 s92, s33, 10
    v_add_u32 v112, s92, v0
    v_and_b32 v13, 0x230, v0
    v_and_b32 v15, 0x40, v0
    v_lshl_add_u32 v13, v15, 1, v13
    v_and_b32 v15, 0x80, v0
    v_lshrrev_b32 v15, 1, v15
    s_lshl_b32 s92, s33, 10
    s_add_u32 s92, s92, 2048
    v_add3_u32 v113, v13, v15, s92
    v_and_b32 v117, 0xf0, v0
    v_add_u32 v13, 4096, v117
    s_mov_b32 s60, 0x0000ffff
    s_mov_b32 s61, 0x0000ffff
    v_cndmask_b32 v113, v13, v113, s[60:61]
    s_lshr_b32 s92, s32, 1
    s_mul_i32 s92, s92, 4608
    s_and_b32 s93, s31, 1
    s_lshl_b32 s93, s93, 10
    s_add_u32 s92, s92, s93
    s_lshl_b32 s93, s33, 11
    s_add_u32 s92, s92, s93
    v_add_u32 v114, s92, v0
    s_lshl_b32 s92, s31, 12
    s_add_u32 s92, s92, 65536
    v_add_u32 v115, s92, v0
    v_add_u32 v116, 98304, v0
    v_lshrrev_b32 v15, 4, v1
    v_lshl_add_u32 v123, v15, 9, v117
    v_lshl_add_u32 v119, v15, 1, v117
    s_lshl_b32 s92, s32, 8
    s_lshl_b32 s93, s33, 3
    s_add_u32 s92, s92, s93
    s_add_u32 s92, s92, 98304
    v_add_u32 v119, s92, v119
    v_lshlrev_b32 v118, 8, v117
    v_lshl_add_u32 v118, v15, 2, v118
    v_lshl_add_u32 v117, v15, 12, v117
    v_and_b32 v13, 7, v1
    v_lshlrev_b32 v120, 8, v13
    v_and_b32 v13, 31, v1
    v_lshlrev_b32 v121, 2, v13
    s_lshl_b32 s63, s39, 16
    s_lshl_b32 s92, s32, 10
    s_add_u32 s63, s63, s92
    s_lshl_b32 s92, s33, 21
    s_add_u32 s63, s63, s92
    s_add_u32 s63, s63, 2097152
    s_lshl_b32 s98, s41, 3
    s_add_u32 s98, s98, s31
    s_lshl_b32 s98, s98, 14
    s_add_u32 s98, s98, 18874368
    s_lshl_b32 s100, s36, 3
    s_add_u32 s100, s100, s40
    s_lshl_b32 s101, s100, 16
    s_lshl_b32 s93, s31, 12
    s_add_u32 s101, s101, s93
    s_add_u32 s101, s101, 13631488
    v_lshrrev_b32 v13, 5, v1
    v_mul_u32_u24 v13, 4096, v13
    s_min_u32 s92, s31, 5
    s_mul_i32 s92, s92, 9216
    s_add_u32 s92, s92, 4096
    v_add3_u32 v12, v13, v0, s92
    v_and_b32 v13, 11, v1
    v_cmp_eq_u32 s[58:59], 0, v13
    v_mov_b32 v13, 0x3f803f80
    s_mov_b32 s48, 0x3fb8aa3b
    v_cndmask_b32 v124, 0, v13, s[58:59]
    s_lshl_b32 s76, s36, 9
    s_add_u32 s76, s76, 17825792
    s_lshr_b32 s92, s40, 1
    s_lshl_b32 s92, s92, 7
    s_and_b32 s93, s40, 1
    s_lshl_b32 s93, s93, 3
    s_add_u32 s92, s92, s93
    s_add_u32 s92, s92, s76
    s_add_u32 s76, s76, 4224
    s_add_u32 s93, s92, 4
    v_lshl_add_u32 v127, v1, 2, s76
    v_writelane_b32 v127, s92, 4
    v_writelane_b32 v127, s93, 5
    s_add_u32 s76, s76, 256
    v_writelane_b32 v127, s76, 6
    v_and_b32 v13, 8, v1
    v_mad_u32_u24 v127, v13, 28, v127
    s_lshr_b32 s77, s28, 1
    s_lshl_b32 s77, s77, 9
    s_and_b32 s92, s30, 4
    s_lshl_b32 s92, s92, 6
    s_add_u32 s77, s77, s92
    s_and_b32 s92, s30, 3
    s_lshl_b32 s92, s92, 2
    s_add_u32 s77, s77, s92
    s_add_u32 s77, s77, 17830016
    s_lshl_b32 s38, s45, 6
    s_add_u32 s38, s38, s39
    s_lshl_b32 s38, s38, 10
    s_add_u32 s38, s38, 13664256
    s_waitcnt vmcnt(7)
    s_barrier
    ds_read_b128 v[128:131], v5 offset:0
    ds_read_b128 v[132:135], v5 offset:2048
    ds_read_b64_tr_b16 v[64:65], v7 offset:0
    ds_read_b64_tr_b16 v[66:67], v7 offset:512
    ds_read_b64_tr_b16 v[68:69], v8 offset:0
    ds_read_b64_tr_b16 v[70:71], v8 offset:512
    ds_read_b128 v[136:139], v6 offset:0
    ds_read_b128 v[140:143], v6 offset:2048
    ds_read_b64_tr_b16 v[72:73], v7 offset:1024
    ds_read_b64_tr_b16 v[74:75], v7 offset:1536
    ds_read_b64_tr_b16 v[76:77], v8 offset:1024
    ds_read_b64_tr_b16 v[78:79], v8 offset:1536
    ds_read_b64_tr_b16 v[80:81], v7 offset:8192
    ds_read_b64_tr_b16 v[82:83], v7 offset:8704
    ds_read_b64_tr_b16 v[84:85], v8 offset:8192
    ds_read_b64_tr_b16 v[86:87], v8 offset:8704
    ds_read_b64_tr_b16 v[88:89], v7 offset:9216
    ds_read_b64_tr_b16 v[90:91], v7 offset:9728
    ds_read_b64_tr_b16 v[92:93], v8 offset:9216
    ds_read_b64_tr_b16 v[94:95], v8 offset:9728
    s_add_u32 m0, s46, 32768
    s_nop 0
    buffer_load_dwordx4 v2, s[8:11], s66 offen lds
    buffer_load_dwordx4 v3, s[8:11], s66 offen offset:1024 lds
    s_add_u32 m0, s46, 97280
    s_nop 0
    buffer_load_dwordx4 v4, s[12:15], s67 offen offset:1024 lds
    buffer_load_dwordx4 v4, s[12:15], s67 offen offset:2048 lds
    s_waitcnt vmcnt(7) lgkmcnt(12)
    s_barrier
    s_add_u32 m0, s46, 49152
    v_mfma_f32_16x16x32_bf16 v[16:19], v[64:67], v[128:131], 0
    ds_read_b128 v[144:147], v5 offset:16384
    buffer_load_dwordx4 v2, s[8:11], s70 offen lds
    v_mfma_f32_16x16x32_bf16 v[20:23], v[64:67], v[132:135], 0
    ds_read_b64_tr_b16 v[64:65], v7 offset:16384
    ds_read_b64_tr_b16 v[66:67], v7 offset:16896
    s_lshr_b32 s92, s36, 1
    s_lshl_b32 s92, s92, 3
    s_add_u32 s92, s92, s40
    s_lshl_b32 s93, s41, 2
    s_add_u32 s93, s93, s31
    s_lshl_b32 s94, s92, 14
    s_lshl_b32 s95, s93, 6
    s_add_u32 s94, s94, s95
    s_and_b32 s99, s36, 1
    s_lshl_b32 s99, s99, 4
    s_add_u32 s99, s99, s93
    s_lshl_b32 s99, s99, 15
    s_lshl_b32 s92, s92, 9
    s_add_u32 s99, s99, s92
    s_add_u32 s99, s99, 18874368
    v_mfma_f32_16x16x32_bf16 v[24:27], v[68:71], v[128:131], 0
    ds_read_b128 v[148:151], v5 offset:18432
    v_mfma_f32_16x16x32_bf16 v[28:31], v[68:71], v[132:135], 0
    ds_read_b64_tr_b16 v[68:69], v8 offset:16384
    ds_read_b64_tr_b16 v[70:71], v8 offset:16896
    buffer_load_dwordx4 v3, s[8:11], s70 offen offset:1024 lds
    s_waitcnt lgkmcnt(14)
    v_mfma_f32_16x16x32_bf16 v[32:35], v[128:131], v[72:75], 0
    ds_read_b128 v[152:155], v6 offset:16384
    v_mfma_f32_16x16x32_bf16 v[36:39], v[132:135], v[72:75], 0
    ds_read_b64_tr_b16 v[72:73], v7 offset:17408
    ds_read_b64_tr_b16 v[74:75], v7 offset:17920
    s_add_u32 m0, s46, 113664
    v_mfma_f32_16x16x32_bf16 v[40:43], v[128:131], v[76:79], 0
    ds_read_b128 v[156:159], v6 offset:18432
    buffer_load_dwordx4 v4, s[12:15], s71 offen offset:1024 lds
    v_mfma_f32_16x16x32_bf16 v[44:47], v[132:135], v[76:79], 0
    ds_read_b64_tr_b16 v[76:77], v8 offset:17408
    ds_read_b64_tr_b16 v[78:79], v8 offset:17920
    s_waitcnt lgkmcnt(15)
    v_mfma_f32_16x16x32_bf16 v[16:19], v[80:83], v[136:139], v[16:19]
    v_mfma_f32_16x16x32_bf16 v[20:23], v[80:83], v[140:143], v[20:23]
    ds_read_b64_tr_b16 v[80:81], v7 offset:24576
    ds_read_b64_tr_b16 v[82:83], v7 offset:25088
    buffer_load_dwordx4 v4, s[12:15], s71 offen offset:2048 lds
    v_mfma_f32_16x16x32_bf16 v[24:27], v[84:87], v[136:139], v[24:27]
    v_mfma_f32_16x16x32_bf16 v[28:31], v[84:87], v[140:143], v[28:31]
    ds_read_b64_tr_b16 v[84:85], v8 offset:24576
    ds_read_b64_tr_b16 v[86:87], v8 offset:25088
    s_mov_b32 s24, s80
    s_mov_b32 s25, s81
    s_mov_b32 s26, 0x200000
    s_mov_b32 s49, 0x3eb8aa3b
    s_mov_b32 s50, 0x42700000
    s_waitcnt lgkmcnt(15)
    s_add_u32 m0, s46, 0
    v_mfma_f32_16x16x32_bf16 v[32:35], v[136:139], v[88:91], v[32:35]
    buffer_load_dwordx4 v2, s[8:11], s72 offen lds
    v_mfma_f32_16x16x32_bf16 v[36:39], v[140:143], v[88:91], v[36:39]
    ds_read_b64_tr_b16 v[88:89], v7 offset:25600
    ds_read_b64_tr_b16 v[90:91], v7 offset:26112
    v_mfma_f32_16x16x32_bf16 v[40:43], v[136:139], v[92:95], v[40:43]
    v_mfma_f32_16x16x32_bf16 v[44:47], v[140:143], v[92:95], v[44:47]
    ds_read_b64_tr_b16 v[92:93], v8 offset:25600
    ds_read_b64_tr_b16 v[94:95], v8 offset:26112
    buffer_load_dwordx4 v3, s[8:11], s72 offen offset:1024 lds
    s_add_u32 m0, s46, 130048
    s_nop 0
    buffer_load_dwordx4 v4, s[12:15], s73 offen offset:1024 lds
    buffer_load_dwordx4 v4, s[12:15], s73 offen offset:2048 lds
    s_waitcnt vmcnt(8) lgkmcnt(8)
    s_barrier
    s_add_u32 m0, s46, 16384
    v_mfma_f32_16x16x32_bf16 v[16:19], v[64:67], v[144:147], v[16:19]
    ds_read_b128 v[160:163], v5 offset:32768
    buffer_load_dwordx4 v2, s[8:11], s74 offen lds
    v_mfma_f32_16x16x32_bf16 v[20:23], v[64:67], v[148:151], v[20:23]
    ds_read_b64_tr_b16 v[64:65], v7 offset:32768
    ds_read_b64_tr_b16 v[66:67], v7 offset:33280
    s_lshl_b32 s88, s39, 16
    s_add_u32 s88, s88, 10485760
    s_lshl_b32 s93, s31, 8
    s_add_u32 s88, s88, s93
    s_mov_b32 s89, s88
    v_mfma_f32_16x16x32_bf16 v[24:27], v[68:71], v[144:147], v[24:27]
    ds_read_b128 v[164:167], v5 offset:34816
    v_mfma_f32_16x16x32_bf16 v[28:31], v[68:71], v[148:151], v[28:31]
    ds_read_b64_tr_b16 v[68:69], v8 offset:32768
    ds_read_b64_tr_b16 v[70:71], v8 offset:33280
    buffer_load_dwordx4 v3, s[8:11], s74 offen offset:1024 lds
    v_mfma_f32_16x16x32_bf16 v[32:35], v[144:147], v[72:75], v[32:35]
    ds_read_b128 v[168:171], v6 offset:32768
    s_lshl_b32 s90, s39, 6
    s_add_u32 s93, s90, s62
    s_add_u32 s90, s90, s45
    s_lshl_b32 s90, s90, 11
    s_add_u32 s90, s90, 6291456
    s_lshl_b32 s29, s93, 10
    s_lshl_b32 s91, s62, 9
    s_add_u32 s91, s91, 12582912
    s_xor_b32 s34, s29, 1024
    v_mfma_f32_16x16x32_bf16 v[36:39], v[148:151], v[72:75], v[36:39]
    ds_read_b64_tr_b16 v[72:73], v7 offset:33792
    ds_read_b64_tr_b16 v[74:75], v7 offset:34304
    s_add_u32 m0, s46, 146432
    v_mfma_f32_16x16x32_bf16 v[40:43], v[144:147], v[76:79], v[40:43]
    ds_read_b128 v[172:175], v6 offset:34816
    buffer_load_dwordx4 v4, s[12:15], s75 offen offset:1024 lds
    v_mfma_f32_16x16x32_bf16 v[44:47], v[148:151], v[76:79], v[44:47]
    ds_read_b64_tr_b16 v[76:77], v8 offset:33792
    ds_read_b64_tr_b16 v[78:79], v8 offset:34304
    s_waitcnt lgkmcnt(12)
    v_mfma_f32_16x16x32_bf16 v[16:19], v[80:83], v[152:155], v[16:19]
    v_mfma_f32_16x16x32_bf16 v[20:23], v[80:83], v[156:159], v[20:23]
    ds_read_b64_tr_b16 v[80:81], v7 offset:40960
    ds_read_b64_tr_b16 v[82:83], v7 offset:41472
    buffer_load_dwordx4 v4, s[12:15], s75 offen offset:2048 lds
    v_mfma_f32_16x16x32_bf16 v[24:27], v[84:87], v[152:155], v[24:27]
    v_mfma_f32_16x16x32_bf16 v[28:31], v[84:87], v[156:159], v[28:31]
    ds_read_b64_tr_b16 v[84:85], v8 offset:40960
    ds_read_b64_tr_b16 v[86:87], v8 offset:41472
    s_lshl_b32 s52, s52, 11
    s_add_u32 s52, s52, 6291456
    v_mfma_f32_16x16x32_bf16 v[32:35], v[152:155], v[88:91], v[32:35]
    v_mov_b32 v244, 0
    v_add_u32 v110, s47, v0
    v_mfma_f32_16x16x32_bf16 v[36:39], v[156:159], v[88:91], v[36:39]
    ds_read_b64_tr_b16 v[88:89], v7 offset:41984
    ds_read_b64_tr_b16 v[90:91], v7 offset:42496
    v_lshl_add_u32 v111, v1, 3, s47
    s_lshl_b32 s35, s31, 8
    s_add_u32 s35, s35, s42
    s_cmp_lg_u32 s35, 640
    s_cbranch_scc1 L_noinit
    v_mov_b32 v15, 1
    s_mov_b32 exec_hi, 0
    buffer_store_dword v15, v121, s[4:7], 0 offen sc1
    s_mov_b32 exec_hi, -1
L_noinit:
    v_mfma_f32_16x16x32_bf16 v[40:43], v[152:155], v[92:95], v[40:43]
    v_mfma_f32_16x16x32_bf16 v[44:47], v[156:159], v[92:95], v[44:47]
    ds_read_b64_tr_b16 v[92:93], v8 offset:41984
    ds_read_b64_tr_b16 v[94:95], v8 offset:42496
    s_waitcnt vmcnt(8) lgkmcnt(8)
    s_barrier
    s_add_u32 m0, s46, 32768
    v_mfma_f32_16x16x32_bf16 v[16:19], v[64:67], v[160:163], v[16:19]
    ds_read_b128 v[176:179], v5 offset:49152
    buffer_load_dwordx4 v2, s[8:11], s78 offen lds
    v_mfma_f32_16x16x32_bf16 v[20:23], v[64:67], v[164:167], v[20:23]
    ds_read_b64_tr_b16 v[64:65], v7 offset:49152
    ds_read_b64_tr_b16 v[66:67], v7 offset:49664
    v_mfma_f32_16x16x32_bf16 v[24:27], v[68:71], v[160:163], v[24:27]
    ds_read_b128 v[180:183], v5 offset:51200
    s_waitcnt vmcnt(17)
    v_dot2c_f32_bf16 v244, v248, v252
    v_mfma_f32_16x16x32_bf16 v[28:31], v[68:71], v[164:167], v[28:31]
    ds_read_b64_tr_b16 v[68:69], v8 offset:49152
    ds_read_b64_tr_b16 v[70:71], v8 offset:49664
    buffer_load_dwordx4 v3, s[8:11], s78 offen offset:1024 lds
    v_mfma_f32_16x16x32_bf16 v[32:35], v[160:163], v[72:75], v[32:35]
    ds_read_b128 v[184:187], v6 offset:49152
    v_dot2c_f32_bf16 v244, v249, v253
    v_dot2c_f32_bf16 v244, v250, v254
    v_mfma_f32_16x16x32_bf16 v[36:39], v[164:167], v[72:75], v[36:39]
    ds_read_b64_tr_b16 v[72:73], v7 offset:50176
    ds_read_b64_tr_b16 v[74:75], v7 offset:50688
    v_dot2c_f32_bf16 v244, v251, v255
    s_add_u32 m0, s46, 64512
    v_mfma_f32_16x16x32_bf16 v[40:43], v[160:163], v[76:79], v[40:43]
    ds_read_b128 v[188:191], v6 offset:51200
    buffer_load_dwordx4 v4, s[12:15], s79 offen offset:1024 lds
    v_mfma_f32_16x16x32_bf16 v[44:47], v[164:167], v[76:79], v[44:47]
    ds_read_b64_tr_b16 v[76:77], v8 offset:50176
    ds_read_b64_tr_b16 v[78:79], v8 offset:50688
    v_add_f32_dpp v244, v244, v244 quad_perm:[1,0,3,2] row_mask:0xf bank_mask:0xf
    s_waitcnt lgkmcnt(12)
    v_mfma_f32_16x16x32_bf16 v[16:19], v[80:83], v[168:171], v[16:19]
    v_add_f32_dpp v244, v244, v244 quad_perm:[2,3,0,1] row_mask:0xf bank_mask:0xf
    v_mfma_f32_16x16x32_bf16 v[20:23], v[80:83], v[172:175], v[20:23]
    ds_read_b64_tr_b16 v[80:81], v7 offset:57344
    ds_read_b64_tr_b16 v[82:83], v7 offset:57856
    buffer_load_dwordx4 v4, s[12:15], s79 offen offset:2048 lds
    v_mfma_f32_16x16x32_bf16 v[24:27], v[84:87], v[168:171], v[24:27]
    v_add_f32_dpp v244, v244, v244 row_half_mirror row_mask:0xf bank_mask:0xf
    v_mfma_f32_16x16x32_bf16 v[28:31], v[84:87], v[172:175], v[28:31]
    ds_read_b64_tr_b16 v[84:85], v8 offset:57344
    ds_read_b64_tr_b16 v[86:87], v8 offset:57856
    v_add_f32_dpp v244, v244, v244 row_mirror row_mask:0xf bank_mask:0xf
    v_mov_b32 v252, v244
    v_mfma_f32_16x16x32_bf16 v[32:35], v[168:171], v[88:91], v[32:35]
    v_mov_b32 v253, v244
    v_mfma_f32_16x16x32_bf16 v[36:39], v[172:175], v[88:91], v[36:39]
    ds_read_b64_tr_b16 v[88:89], v7 offset:58368
    ds_read_b64_tr_b16 v[90:91], v7 offset:58880
    v_permlane32_swap_b32 v252, v253
    v_add_f32 v244, v252, v253
    v_mfma_f32_16x16x32_bf16 v[40:43], v[168:171], v[92:95], v[40:43]
    v_mov_b32 v252, v244
    v_mov_b32 v253, v244
    v_mfma_f32_16x16x32_bf16 v[44:47], v[172:175], v[92:95], v[44:47]
    ds_read_b64_tr_b16 v[92:93], v8 offset:58368
    ds_read_b64_tr_b16 v[94:95], v8 offset:58880
    v_permlane16_swap_b32 v252, v253
    v_add_f32 v244, v252, v253
    s_waitcnt vmcnt(8) lgkmcnt(8)
    s_barrier
    s_add_u32 m0, s46, 49152
    v_mfma_f32_16x16x32_bf16 v[16:19], v[64:67], v[176:179], v[16:19]
    ds_read_b128 v[192:195], v5 offset:0
    buffer_load_dwordx4 v2, s[8:11], s68 offen lds
    v_mfma_f32_16x16x32_bf16 v[20:23], v[64:67], v[180:183], v[20:23]
    ds_read_b64_tr_b16 v[64:65], v9 offset:0
    ds_read_b64_tr_b16 v[66:67], v9 offset:512
    v_mul_f32 v244, s48, v244
    v_exp_f32 v244, -v244
    v_mfma_f32_16x16x32_bf16 v[24:27], v[68:71], v[176:179], v[24:27]
    ds_read_b128 v[196:199], v5 offset:2048
    v_add_f32 v244, 1.0, v244
    v_mfma_f32_16x16x32_bf16 v[28:31], v[68:71], v[180:183], v[28:31]
    ds_read_b64_tr_b16 v[68:69], v11 offset:0
    ds_read_b64_tr_b16 v[70:71], v11 offset:512
    buffer_load_dwordx4 v3, s[8:11], s68 offen offset:1024 lds
    v_mfma_f32_16x16x32_bf16 v[32:35], v[176:179], v[72:75], v[32:35]
    ds_read_b128 v[200:203], v6 offset:0
    v_mfma_f32_16x16x32_bf16 v[36:39], v[180:183], v[72:75], v[36:39]
    ds_read_b64_tr_b16 v[72:73], v9 offset:1024
    ds_read_b64_tr_b16 v[74:75], v9 offset:1536
    s_add_u32 m0, s46, 80896
    v_mfma_f32_16x16x32_bf16 v[40:43], v[176:179], v[76:79], v[40:43]
    ds_read_b128 v[204:207], v6 offset:2048
    buffer_load_dwordx4 v4, s[12:15], s69 offen offset:1024 lds
    v_mfma_f32_16x16x32_bf16 v[44:47], v[180:183], v[76:79], v[44:47]
    ds_read_b64_tr_b16 v[76:77], v11 offset:1024
    ds_read_b64_tr_b16 v[78:79], v11 offset:1536
    s_waitcnt lgkmcnt(12)
    v_mfma_f32_16x16x32_bf16 v[16:19], v[80:83], v[184:187], v[16:19]
    v_mfma_f32_16x16x32_bf16 v[20:23], v[80:83], v[188:191], v[20:23]
    ds_read_b64_tr_b16 v[80:81], v9 offset:8192
    ds_read_b64_tr_b16 v[82:83], v9 offset:8704
    buffer_load_dwordx4 v4, s[12:15], s69 offen offset:2048 lds
    v_mfma_f32_16x16x32_bf16 v[24:27], v[84:87], v[184:187], v[24:27]
    v_mfma_f32_16x16x32_bf16 v[28:31], v[84:87], v[188:191], v[28:31]
    ds_read_b64_tr_b16 v[84:85], v11 offset:8192
    ds_read_b64_tr_b16 v[86:87], v11 offset:8704
    v_mfma_f32_16x16x32_bf16 v[32:35], v[184:187], v[88:91], v[32:35]
    v_mfma_f32_16x16x32_bf16 v[36:39], v[188:191], v[88:91], v[36:39]
    ds_read_b64_tr_b16 v[88:89], v9 offset:9216
    ds_read_b64_tr_b16 v[90:91], v9 offset:9728
    v_mfma_f32_16x16x32_bf16 v[40:43], v[184:187], v[92:95], v[40:43]
    v_mfma_f32_16x16x32_bf16 v[44:47], v[188:191], v[92:95], v[44:47]
    ds_read_b64_tr_b16 v[92:93], v11 offset:9216
    ds_read_b64_tr_b16 v[94:95], v11 offset:9728
    s_waitcnt vmcnt(8) lgkmcnt(8)
    s_barrier
    s_add_u32 m0, s46, 98304
    v_mfma_f32_16x16x32_bf16 v[16:19], v[64:67], v[192:195], v[16:19]
    ds_read_b128 v[208:211], v5 offset:16384
    buffer_load_dwordx4 v4, s[16:19], s37 offen offset:0 lds
    v_mfma_f32_16x16x32_bf16 v[20:23], v[64:67], v[196:199], v[20:23]
    ds_read_b64_tr_b16 v[64:65], v9 offset:16384
    ds_read_b64_tr_b16 v[66:67], v9 offset:16896
    ds_write_b128 v110, v[240:243] offset:0
    ds_read_b64_tr_b16 v[98:99], v111 offset:0
    ds_read_b64_tr_b16 v[102:103], v111 offset:512
    v_mfma_f32_16x16x32_bf16 v[24:27], v[68:71], v[192:195], v[24:27]
    ds_read_b128 v[212:215], v5 offset:18432
    v_rcp_f32 v110, v244
    s_add_u32 m0, s46, 99328
    v_mfma_f32_16x16x32_bf16 v[28:31], v[68:71], v[196:199], v[28:31]
    ds_read_b64_tr_b16 v[68:69], v11 offset:16384
    ds_read_b64_tr_b16 v[70:71], v11 offset:16896
    buffer_load_dwordx4 v4, s[16:19], s65 offen offset:0 lds
    v_mfma_f32_16x16x32_bf16 v[32:35], v[192:195], v[72:75], v[32:35]
    ds_read_b128 v[216:219], v6 offset:16384
    s_lshl_b32 s92, s31, 2
    v_mov_b32 v252, s92
    v_mfma_f32_16x16x32_bf16 v[36:39], v[196:199], v[72:75], v[36:39]
    ds_read_b64_tr_b16 v[72:73], v9 offset:17408
    ds_read_b64_tr_b16 v[74:75], v9 offset:17920
    ds_write_b32 v252, v110 offset:8192
    v_mfma_f32_16x16x32_bf16 v[40:43], v[192:195], v[76:79], v[40:43]
    ds_read_b128 v[220:223], v6 offset:18432
    v_mfma_f32_16x16x32_bf16 v[44:47], v[196:199], v[76:79], v[44:47]
    ds_read_b64_tr_b16 v[76:77], v11 offset:17408
    ds_read_b64_tr_b16 v[78:79], v11 offset:17920
    s_waitcnt lgkmcnt(15)
    v_mfma_f32_16x16x32_bf16 v[16:19], v[80:83], v[200:203], v[16:19]
    v_mfma_f32_16x16x32_bf16 v[20:23], v[80:83], v[204:207], v[20:23]
    ds_read_b64_tr_b16 v[80:81], v9 offset:24576
    ds_read_b64_tr_b16 v[82:83], v9 offset:25088
    v_mfma_f32_16x16x32_bf16 v[24:27], v[84:87], v[200:203], v[24:27]
    v_mfma_f32_16x16x32_bf16 v[28:31], v[84:87], v[204:207], v[28:31]
    ds_read_b64_tr_b16 v[84:85], v11 offset:24576
    ds_read_b64_tr_b16 v[86:87], v11 offset:25088
    v_mfma_f32_16x16x32_bf16 v[32:35], v[200:203], v[88:91], v[32:35]
    v_mfma_f32_16x16x32_bf16 v[36:39], v[204:207], v[88:91], v[36:39]
    ds_read_b64_tr_b16 v[88:89], v9 offset:25600
    ds_read_b64_tr_b16 v[90:91], v9 offset:26112
    v_mfma_f32_16x16x32_bf16 v[40:43], v[200:203], v[92:95], v[40:43]
    v_mfma_f32_16x16x32_bf16 v[44:47], v[204:207], v[92:95], v[44:47]
    ds_read_b64_tr_b16 v[92:93], v11 offset:25600
    ds_read_b64_tr_b16 v[94:95], v11 offset:26112
    s_waitcnt vmcnt(6) lgkmcnt(8)
    s_barrier
    s_add_u32 m0, s46, 114688
    v_mfma_f32_16x16x32_bf16 v[16:19], v[64:67], v[208:211], v[16:19]
    ds_read_b128 v[224:227], v5 offset:32768
    buffer_load_dwordx4 v4, s[16:19], s67 offen offset:0 lds
    v_mfma_f32_16x16x32_bf16 v[20:23], v[64:67], v[212:215], v[20:23]
    ds_read_b64_tr_b16 v[64:65], v7 offset:0
    ds_read_b64_tr_b16 v[66:67], v7 offset:512
    s_waitcnt lgkmcnt(15)
    v_lshlrev_b32 v13, 16, v98
    v_and_b32 v15, 0xffff0000, v98
    v_mfma_f32_16x16x32_bf16 v[24:27], v[68:71], v[208:211], v[24:27]
    ds_read_b128 v[228:231], v5 offset:34816
    v_mul_f32 v13, s48, v13
    v_mul_f32 v15, s48, v15
    s_add_u32 m0, s46, 115712
    v_mfma_f32_16x16x32_bf16 v[28:31], v[68:71], v[212:215], v[28:31]
    ds_read_b64_tr_b16 v[68:69], v8 offset:0
    ds_read_b64_tr_b16 v[70:71], v8 offset:512
    buffer_load_dwordx4 v4, s[16:19], s71 offen offset:0 lds
    v_mfma_f32_16x16x32_bf16 v[32:35], v[208:211], v[72:75], v[32:35]
    ds_read_b128 v[232:235], v6 offset:32768
    v_cvt_pk_bf16_f32 v98, v13, v15
    v_lshlrev_b32 v13, 16, v99
    v_mfma_f32_16x16x32_bf16 v[36:39], v[212:215], v[72:75], v[36:39]
    ds_read_b64_tr_b16 v[72:73], v7 offset:1024
    ds_read_b64_tr_b16 v[74:75], v7 offset:1536
    v_and_b32 v15, 0xffff0000, v99
    v_mul_f32 v13, s48, v13
    v_mfma_f32_16x16x32_bf16 v[40:43], v[208:211], v[76:79], v[40:43]
    ds_read_b128 v[236:239], v6 offset:34816
    v_mul_f32 v15, s48, v15
    v_cvt_pk_bf16_f32 v99, v13, v15
    v_mfma_f32_16x16x32_bf16 v[44:47], v[212:215], v[76:79], v[44:47]
    ds_read_b64_tr_b16 v[76:77], v8 offset:1024
    ds_read_b64_tr_b16 v[78:79], v8 offset:1536
    v_lshlrev_b32 v13, 16, v102
    v_and_b32 v15, 0xffff0000, v102
    s_waitcnt lgkmcnt(12)
    v_mfma_f32_16x16x32_bf16 v[16:19], v[80:83], v[216:219], v[16:19]
    v_mul_f32 v13, s48, v13
    v_mul_f32 v15, s48, v15
    v_mfma_f32_16x16x32_bf16 v[20:23], v[80:83], v[220:223], v[20:23]
    ds_read_b64_tr_b16 v[80:81], v7 offset:8192
    ds_read_b64_tr_b16 v[82:83], v7 offset:8704
    v_cvt_pk_bf16_f32 v102, v13, v15
    v_lshlrev_b32 v13, 16, v103
    v_mfma_f32_16x16x32_bf16 v[24:27], v[84:87], v[216:219], v[24:27]
    v_and_b32 v15, 0xffff0000, v103
    v_mul_f32 v13, s48, v13
    v_mfma_f32_16x16x32_bf16 v[28:31], v[84:87], v[220:223], v[28:31]
    ds_read_b64_tr_b16 v[84:85], v8 offset:8192
    ds_read_b64_tr_b16 v[86:87], v8 offset:8704
    v_mul_f32 v15, s48, v15
    v_cvt_pk_bf16_f32 v103, v13, v15
    v_mfma_f32_16x16x32_bf16 v[32:35], v[216:219], v[88:91], v[32:35]
    v_mfma_f32_16x16x32_bf16 v[36:39], v[220:223], v[88:91], v[36:39]
    ds_read_b64_tr_b16 v[88:89], v7 offset:9216
    ds_read_b64_tr_b16 v[90:91], v7 offset:9728
    v_mfma_f32_16x16x32_bf16 v[40:43], v[216:219], v[92:95], v[40:43]
    v_mfma_f32_16x16x32_bf16 v[44:47], v[220:223], v[92:95], v[44:47]
    ds_read_b64_tr_b16 v[92:93], v8 offset:9216
    ds_read_b64_tr_b16 v[94:95], v8 offset:9728
    s_waitcnt vmcnt(4) lgkmcnt(8)
    s_barrier
    s_add_u32 m0, s46, 131072
    v_mfma_f32_16x16x32_bf16 v[16:19], v[64:67], v[224:227], v[16:19]
    ds_read_b128 v[240:243], v5 offset:49152
    buffer_load_dwordx4 v4, s[16:19], s73 offen offset:0 lds
    v_mfma_f32_16x16x32_bf16 v[20:23], v[64:67], v[228:231], v[20:23]
    ds_read_b64_tr_b16 v[64:65], v7 offset:16384
    ds_read_b64_tr_b16 v[66:67], v7 offset:16896
    v_mfma_f32_16x16x32_bf16 v[24:27], v[68:71], v[224:227], v[24:27]
    ds_read_b128 v[244:247], v5 offset:51200
    s_add_u32 m0, s46, 132096
    v_mfma_f32_16x16x32_bf16 v[28:31], v[68:71], v[228:231], v[28:31]
    ds_read_b64_tr_b16 v[68:69], v8 offset:16384
    ds_read_b64_tr_b16 v[70:71], v8 offset:16896
    buffer_load_dwordx4 v4, s[16:19], s75 offen offset:0 lds
    v_mfma_f32_16x16x32_bf16 v[32:35], v[224:227], v[72:75], v[32:35]
    ds_read_b128 v[248:251], v6 offset:49152
    v_mfma_f32_16x16x32_bf16 v[36:39], v[228:231], v[72:75], v[36:39]
    ds_read_b64_tr_b16 v[72:73], v7 offset:17408
    ds_read_b64_tr_b16 v[74:75], v7 offset:17920
    v_mfma_f32_16x16x32_bf16 v[40:43], v[224:227], v[76:79], v[40:43]
    ds_read_b128 v[252:255], v6 offset:51200
    v_mfma_f32_16x16x32_bf16 v[44:47], v[228:231], v[76:79], v[44:47]
    ds_read_b64_tr_b16 v[76:77], v8 offset:17408
    ds_read_b64_tr_b16 v[78:79], v8 offset:17920
    s_waitcnt lgkmcnt(12)
    v_mfma_f32_16x16x32_bf16 v[16:19], v[80:83], v[232:235], v[16:19]
    v_mfma_f32_16x16x32_bf16 v[20:23], v[80:83], v[236:239], v[20:23]
    ds_read_b64_tr_b16 v[80:81], v7 offset:24576
    ds_read_b64_tr_b16 v[82:83], v7 offset:25088
    v_mfma_f32_16x16x32_bf16 v[24:27], v[84:87], v[232:235], v[24:27]
    v_mfma_f32_16x16x32_bf16 v[28:31], v[84:87], v[236:239], v[28:31]
    ds_read_b64_tr_b16 v[84:85], v8 offset:24576
    ds_read_b64_tr_b16 v[86:87], v8 offset:25088
    v_mfma_f32_16x16x32_bf16 v[32:35], v[232:235], v[88:91], v[32:35]
    v_mfma_f32_16x16x32_bf16 v[36:39], v[236:239], v[88:91], v[36:39]
    ds_read_b64_tr_b16 v[88:89], v7 offset:25600
    ds_read_b64_tr_b16 v[90:91], v7 offset:26112
    v_mfma_f32_16x16x32_bf16 v[40:43], v[232:235], v[92:95], v[40:43]
    v_mfma_f32_16x16x32_bf16 v[44:47], v[236:239], v[92:95], v[44:47]
    ds_read_b64_tr_b16 v[92:93], v8 offset:25600
    ds_read_b64_tr_b16 v[94:95], v8 offset:26112
    s_waitcnt vmcnt(2) lgkmcnt(8)
    s_barrier
    s_add_u32 m0, s46, 147456
    v_mfma_f32_16x16x32_bf16 v[16:19], v[64:67], v[240:243], v[16:19]
    buffer_load_dwordx4 v4, s[16:19], s79 offen offset:0 lds
    v_mfma_f32_16x16x32_bf16 v[20:23], v[64:67], v[244:247], v[20:23]
    ds_read_b64_tr_b16 v[64:65], v7 offset:32768
    ds_read_b64_tr_b16 v[66:67], v7 offset:33280
    ds_read_b32 v110, v121 offset:8192
    v_mfma_f32_16x16x32_bf16 v[24:27], v[68:71], v[240:243], v[24:27]
    s_add_u32 m0, s46, 148480
    v_mfma_f32_16x16x32_bf16 v[28:31], v[68:71], v[244:247], v[28:31]
    ds_read_b64_tr_b16 v[68:69], v8 offset:32768
    ds_read_b64_tr_b16 v[70:71], v8 offset:33280
    buffer_load_dwordx4 v4, s[16:19], s69 offen offset:0 lds
    v_mfma_f32_16x16x32_bf16 v[32:35], v[240:243], v[72:75], v[32:35]
    v_mfma_f32_16x16x32_bf16 v[36:39], v[244:247], v[72:75], v[36:39]
    ds_read_b64_tr_b16 v[72:73], v7 offset:40960
    ds_read_b64_tr_b16 v[74:75], v7 offset:41472
    v_mfma_f32_16x16x32_bf16 v[40:43], v[240:243], v[76:79], v[40:43]
    buffer_load_dword v111, v121, s[4:7], 0 offen sc1
    v_mfma_f32_16x16x32_bf16 v[44:47], v[244:247], v[76:79], v[44:47]
    ds_read_b64_tr_b16 v[76:77], v8 offset:40960
    ds_read_b64_tr_b16 v[78:79], v8 offset:41472
    s_waitcnt lgkmcnt(9)
    v_mfma_f32_16x16x32_bf16 v[16:19], v[80:83], v[248:251], v[16:19]
    v_mfma_f32_16x16x32_bf16 v[20:23], v[80:83], v[252:255], v[20:23]
    ds_read_b64_tr_b16 v[80:81], v7 offset:33792
    ds_read_b64_tr_b16 v[82:83], v7 offset:34304
    v_mfma_f32_16x16x32_bf16 v[24:27], v[84:87], v[248:251], v[24:27]
    v_mfma_f32_16x16x32_bf16 v[28:31], v[84:87], v[252:255], v[28:31]
    ds_read_b64_tr_b16 v[84:85], v8 offset:33792
    ds_read_b64_tr_b16 v[86:87], v8 offset:34304
    v_mfma_f32_16x16x32_bf16 v[32:35], v[248:251], v[88:91], v[32:35]
    v_mfma_f32_16x16x32_bf16 v[36:39], v[252:255], v[88:91], v[36:39]
    ds_read_b64_tr_b16 v[88:89], v7 offset:41984
    ds_read_b64_tr_b16 v[90:91], v7 offset:42496
    v_mfma_f32_16x16x32_bf16 v[40:43], v[248:251], v[92:95], v[40:43]
    v_mfma_f32_16x16x32_bf16 v[44:47], v[252:255], v[92:95], v[44:47]
    ds_read_b64_tr_b16 v[92:93], v8 offset:41984
    ds_read_b64_tr_b16 v[94:95], v8 offset:42496
    s_cmp_ge_u32 s40, 4
    s_cbranch_scc1 L_ty2
    s_waitcnt lgkmcnt(8)
    v_mfma_f32_16x16x32_bf16 v[48:51], v[64:67], v[128:131], 0
    v_cvt_pk_bf16_f32 v16, v16, v17
    v_cvt_pk_bf16_f32 v17, v18, v19
    v_cvt_pk_bf16_f32 v18, v20, v21
    v_cvt_pk_bf16_f32 v19, v22, v23
    v_mfma_f32_16x16x32_bf16 v[52:55], v[64:67], v[132:135], 0
    ds_read_b64_tr_b16 v[64:65], v7 offset:49152
    ds_read_b64_tr_b16 v[66:67], v7 offset:49664
    v_cvt_pk_bf16_f32 v32, v32, v33
    v_cvt_pk_bf16_f32 v33, v34, v35
    v_permlane16_swap_b32 v16, v18
    v_permlane16_swap_b32 v17, v19
    v_mfma_f32_16x16x32_bf16 v[56:59], v[68:71], v[128:131], 0
    v_cvt_pk_bf16_f32 v34, v36, v37
    v_cvt_pk_bf16_f32 v35, v38, v39
    s_add_u32 s54, s53, 2097152
    buffer_store_dwordx4 v[16:19], v0, s[20:23], s54 offen sc1
    v_mfma_f32_16x16x32_bf16 v[60:63], v[68:71], v[132:135], 0
    ds_read_b64_tr_b16 v[68:69], v8 offset:49152
    ds_read_b64_tr_b16 v[70:71], v8 offset:49664
    v_cvt_pk_bf16_f32 v24, v24, v25
    v_cvt_pk_bf16_f32 v25, v26, v27
    v_permlane16_swap_b32 v32, v34
    v_permlane16_swap_b32 v33, v35
    v_mfma_f32_16x16x32_bf16 v[48:51], v[72:75], v[136:139], v[48:51]
    v_cvt_pk_bf16_f32 v26, v28, v29
    v_cvt_pk_bf16_f32 v27, v30, v31
    s_add_u32 s54, s53, 4194304
    buffer_store_dwordx4 v[32:35], v0, s[20:23], s54 offen sc1
    v_mfma_f32_16x16x32_bf16 v[52:55], v[72:75], v[140:143], v[52:55]
    ds_read_b64_tr_b16 v[72:73], v7 offset:57344
    ds_read_b64_tr_b16 v[74:75], v7 offset:57856
    v_cvt_pk_bf16_f32 v40, v40, v41
    v_cvt_pk_bf16_f32 v41, v42, v43
    v_permlane16_swap_b32 v24, v26
    v_permlane16_swap_b32 v25, v27
    v_mfma_f32_16x16x32_bf16 v[56:59], v[76:79], v[136:139], v[56:59]
    v_cvt_pk_bf16_f32 v42, v44, v45
    v_cvt_pk_bf16_f32 v43, v46, v47
    s_add_u32 s54, s53, 2162688
    buffer_store_dwordx4 v[24:27], v0, s[20:23], s54 offen sc1
    v_mfma_f32_16x16x32_bf16 v[60:63], v[76:79], v[140:143], v[60:63]
    ds_read_b64_tr_b16 v[76:77], v8 offset:57344
    ds_read_b64_tr_b16 v[78:79], v8 offset:57856
    s_nop 0
    s_nop 0
    v_permlane16_swap_b32 v40, v42
    v_permlane16_swap_b32 v41, v43
    s_waitcnt lgkmcnt(8)
    v_mfma_f32_16x16x32_bf16 v[48:51], v[80:83], v[144:147], v[48:51]
    s_add_u32 s54, s53, 4259840
    buffer_store_dwordx4 v[40:43], v0, s[20:23], s54 offen sc1
    ds_write2_b32 v12, v124, v124 offset1:1
    ds_write2_b32 v12, v124, v124 offset0:2 offset1:3
    v_mfma_f32_16x16x32_bf16 v[52:55], v[80:83], v[148:151], v[52:55]
    ds_read_b64_tr_b16 v[80:81], v7 offset:50176
    ds_read_b64_tr_b16 v[82:83], v7 offset:50688
    ds_write_b32 v121, v96 offset:63488
    v_mfma_f32_16x16x32_bf16 v[56:59], v[84:87], v[144:147], v[56:59]
    v_mfma_f32_16x16x32_bf16 v[60:63], v[84:87], v[148:151], v[60:63]
    ds_read_b64_tr_b16 v[84:85], v8 offset:50176
    ds_read_b64_tr_b16 v[86:87], v8 offset:50688
    v_mfma_f32_16x16x32_bf16 v[48:51], v[88:91], v[152:155], v[48:51]
    v_mfma_f32_16x16x32_bf16 v[52:55], v[88:91], v[156:159], v[52:55]
    ds_read_b64_tr_b16 v[88:89], v7 offset:58368
    ds_read_b64_tr_b16 v[90:91], v7 offset:58880
    v_mfma_f32_16x16x32_bf16 v[56:59], v[92:95], v[152:155], v[56:59]
    v_mfma_f32_16x16x32_bf16 v[60:63], v[92:95], v[156:159], v[60:63]
    ds_read_b64_tr_b16 v[92:93], v8 offset:58368
    ds_read_b64_tr_b16 v[94:95], v8 offset:58880
    s_waitcnt vmcnt(5) lgkmcnt(11)
    s_barrier
    v_mfma_f32_16x16x32_bf16 v[48:51], v[64:67], v[160:163], v[48:51]
    v_mov_b32 v144, 0
    v_mov_b32 v145, 0
    v_mov_b32 v148, 0
    v_mov_b32 v149, 0
    v_mfma_f32_16x16x32_bf16 v[52:55], v[64:67], v[164:167], v[52:55]
    ds_read_b64_tr_b16 v[64:65], v9 offset:0
    ds_read_b64_tr_b16 v[66:67], v9 offset:512
    v_mov_b32 v152, 0
    v_mov_b32 v153, 0
    v_mov_b32 v156, 0
    v_mov_b32 v157, 0
    v_mfma_f32_16x16x32_bf16 v[56:59], v[68:71], v[160:163], v[56:59]
    v_mfma_f32_16x16x32_bf16 v[60:63], v[68:71], v[164:167], v[60:63]
    ds_read_b64_tr_b16 v[68:69], v11 offset:0
    ds_read_b64_tr_b16 v[70:71], v11 offset:512
    v_mfma_f32_16x16x32_bf16 v[48:51], v[72:75], v[168:171], v[48:51]
    v_mfma_f32_16x16x32_bf16 v[52:55], v[72:75], v[172:175], v[52:55]
    ds_read_b64_tr_b16 v[72:73], v9 offset:8192
    ds_read_b64_tr_b16 v[74:75], v9 offset:8704
    v_mfma_f32_16x16x32_bf16 v[56:59], v[76:79], v[168:171], v[56:59]
    v_mfma_f32_16x16x32_bf16 v[60:63], v[76:79], v[172:175], v[60:63]
    ds_read_b64_tr_b16 v[76:77], v11 offset:8192
    ds_read_b64_tr_b16 v[78:79], v11 offset:8704
    s_waitcnt lgkmcnt(8)
    s_waitcnt vmcnt(0)
    v_cmp_eq_u32 vcc, 0, v111
    s_cmp_lg_u64 vcc, 0
    s_cbranch_scc1 L_fs11
L_fb12:
    s_barrier
    s_cmp_lg_u32 s31, 0
    s_cbranch_scc1 L_w0_15
    s_mov_b64 exec, 1
    buffer_store_dword v111, v96, s[20:23], s77 offen sc1
    s_mov_b64 exec, -1
L_w0_15:
    v_mfma_f32_16x16x32_bf16 v[48:51], v[80:83], v[176:179], v[48:51]
    v_mfma_f32_16x16x32_bf16 v[52:55], v[80:83], v[180:183], v[52:55]
    ds_read_b64_tr_b16 v[80:81], v9 offset:1024
    ds_read_b64_tr_b16 v[82:83], v9 offset:1536
    s_add_u32 m0, s47, 55296
    s_nop 0
    buffer_load_dwordx4 v122, s[0:3], s94 offen lds
    v_mfma_f32_16x16x32_bf16 v[56:59], v[84:87], v[176:179], v[56:59]
    v_mfma_f32_16x16x32_bf16 v[60:63], v[84:87], v[180:183], v[60:63]
    ds_read_b64_tr_b16 v[84:85], v11 offset:1024
    ds_read_b64_tr_b16 v[86:87], v11 offset:1536
    v_mfma_f32_16x16x32_bf16 v[48:51], v[88:91], v[184:187], v[48:51]
    v_mfma_f32_16x16x32_bf16 v[52:55], v[88:91], v[188:191], v[52:55]
    ds_read_b64_tr_b16 v[88:89], v9 offset:9216
    ds_read_b64_tr_b16 v[90:91], v9 offset:9728
    v_mfma_f32_16x16x32_bf16 v[56:59], v[92:95], v[184:187], v[56:59]
    v_mfma_f32_16x16x32_bf16 v[60:63], v[92:95], v[188:191], v[60:63]
    ds_read_b64_tr_b16 v[92:93], v11 offset:9216
    ds_read_b64_tr_b16 v[94:95], v11 offset:9728
    s_waitcnt lgkmcnt(8)
    v_mfma_f32_16x16x32_bf16 v[48:51], v[64:67], v[192:195], v[48:51]
    v_mfma_f32_16x16x32_bf16 v[52:55], v[64:67], v[196:199], v[52:55]
    ds_read_b64_tr_b16 v[64:65], v9 offset:16384
    ds_read_b64_tr_b16 v[66:67], v9 offset:16896
    v_mfma_f32_16x16x32_bf16 v[56:59], v[68:71], v[192:195], v[56:59]
    v_mfma_f32_16x16x32_bf16 v[60:63], v[68:71], v[196:199], v[60:63]
    ds_read_b64_tr_b16 v[68:69], v11 offset:16384
    ds_read_b64_tr_b16 v[70:71], v11 offset:16896
    v_mfma_f32_16x16x32_bf16 v[48:51], v[72:75], v[200:203], v[48:51]
    v_mfma_f32_16x16x32_bf16 v[52:55], v[72:75], v[204:207], v[52:55]
    ds_read_b64_tr_b16 v[72:73], v9 offset:24576
    ds_read_b64_tr_b16 v[74:75], v9 offset:25088
    v_mfma_f32_16x16x32_bf16 v[56:59], v[76:79], v[200:203], v[56:59]
    v_mfma_f32_16x16x32_bf16 v[60:63], v[76:79], v[204:207], v[60:63]
    ds_read_b64_tr_b16 v[76:77], v11 offset:24576
    ds_read_b64_tr_b16 v[78:79], v11 offset:25088
    s_waitcnt lgkmcnt(8)
    s_cmp_lg_u32 s31, 1
    s_cbranch_scc1 L_gs8
    s_waitcnt lgkmcnt(15)
    s_mov_b32 exec_hi, 0
    buffer_store_dword v110, v121, s[20:23], s96 offen sc1
    s_mov_b32 exec_hi, -1
L_gs8:
    v_mfma_f32_16x16x32_bf16 v[48:51], v[80:83], v[208:211], v[48:51]
    v_mfma_f32_16x16x32_bf16 v[52:55], v[80:83], v[212:215], v[52:55]
    ds_read_b64_tr_b16 v[80:81], v9 offset:17408
    ds_read_b64_tr_b16 v[82:83], v9 offset:17920
    v_mfma_f32_16x16x32_bf16 v[56:59], v[84:87], v[208:211], v[56:59]
    v_mfma_f32_16x16x32_bf16 v[60:63], v[84:87], v[212:215], v[60:63]
    ds_read_b64_tr_b16 v[84:85], v11 offset:17408
    ds_read_b64_tr_b16 v[86:87], v11 offset:17920
    v_mfma_f32_16x16x32_bf16 v[48:51], v[88:91], v[216:219], v[48:51]
    v_mfma_f32_16x16x32_bf16 v[52:55], v[88:91], v[220:223], v[52:55]
    ds_read_b64_tr_b16 v[88:89], v9 offset:25600
    ds_read_b64_tr_b16 v[90:91], v9 offset:26112
    v_mfma_f32_16x16x32_bf16 v[56:59], v[92:95], v[216:219], v[56:59]
    v_mfma_f32_16x16x32_bf16 v[60:63], v[92:95], v[220:223], v[60:63]
    ds_read_b64_tr_b16 v[92:93], v11 offset:25600
    ds_read_b64_tr_b16 v[94:95], v11 offset:26112
    s_waitcnt lgkmcnt(8)
    v_mfma_f32_16x16x32_bf16 v[48:51], v[64:67], v[224:227], v[48:51]
    v_mfma_f32_16x16x32_bf16 v[52:55], v[64:67], v[228:231], v[52:55]
    v_mfma_f32_16x16x32_bf16 v[56:59], v[68:71], v[224:227], v[56:59]
    v_mfma_f32_16x16x32_bf16 v[60:63], v[68:71], v[228:231], v[60:63]
    v_mfma_f32_16x16x32_bf16 v[48:51], v[72:75], v[232:235], v[48:51]
    v_mfma_f32_16x16x32_bf16 v[52:55], v[72:75], v[236:239], v[52:55]
    v_mfma_f32_16x16x32_bf16 v[56:59], v[76:79], v[232:235], v[56:59]
    v_mfma_f32_16x16x32_bf16 v[60:63], v[76:79], v[236:239], v[60:63]
    s_waitcnt lgkmcnt(0)
    v_mfma_f32_16x16x32_bf16 v[48:51], v[80:83], v[240:243], v[48:51]
    v_mfma_f32_16x16x32_bf16 v[52:55], v[80:83], v[244:247], v[52:55]
    v_mfma_f32_16x16x32_bf16 v[56:59], v[84:87], v[240:243], v[56:59]
    v_mfma_f32_16x16x32_bf16 v[60:63], v[84:87], v[244:247], v[60:63]
    v_mfma_f32_16x16x32_bf16 v[48:51], v[88:91], v[248:251], v[48:51]
    v_mfma_f32_16x16x32_bf16 v[52:55], v[88:91], v[252:255], v[52:55]
    v_mfma_f32_16x16x32_bf16 v[56:59], v[92:95], v[248:251], v[56:59]
    v_mfma_f32_16x16x32_bf16 v[60:63], v[92:95], v[252:255], v[60:63]
    v_mov_b32 v64, 0
    v_mov_b32 v65, 0
    v_mov_b32 v66, 0
    v_mov_b32 v67, 0
    v_mov_b32 v68, 0
    v_cvt_pk_bf16_f32 v48, v48, v49
    v_cvt_pk_bf16_f32 v49, v50, v51
    v_cvt_pk_bf16_f32 v50, v52, v53
    v_cvt_pk_bf16_f32 v51, v54, v55
    v_cvt_pk_bf16_f32 v56, v56, v57
    v_cvt_pk_bf16_f32 v57, v58, v59
    s_mov_b64 exec, 0x3f
    buffer_load_dword v4, v127, s[20:23], 0 offen sc1
    s_mov_b64 exec, -1
    v_mfma_f32_16x16x32_bf16 v[192:195], v[98:101], v[48:51], 0
    v_mfma_f32_16x16x32_bf16 v[196:199], v[96:99], v[48:51], 0
    v_cvt_pk_bf16_f32 v58, v60, v61
    v_cvt_pk_bf16_f32 v59, v62, v63
    v_mov_b32 v69, 0
    v_mov_b32 v70, 0
    v_mfma_f32_16x16x32_bf16 v[200:203], v[102:105], v[56:59], 0
    v_mfma_f32_16x16x32_bf16 v[204:207], v[100:103], v[56:59], 0
    v_mov_b32 v71, 0
    v_exp_f32 v160, v192
    v_exp_f32 v164, -v192
    v_exp_f32 v161, v193
    v_exp_f32 v165, -v193
    v_exp_f32 v162, v194
    v_exp_f32 v166, -v194
    v_exp_f32 v163, v195
    v_exp_f32 v167, -v195
    v_exp_f32 v168, v196
    v_exp_f32 v172, -v196
    v_exp_f32 v169, v197
    v_exp_f32 v173, -v197
    v_exp_f32 v170, v198
    v_exp_f32 v174, -v198
    v_exp_f32 v171, v199
    v_exp_f32 v175, -v199
    v_exp_f32 v176, v200
    v_exp_f32 v180, -v200
    v_exp_f32 v177, v201
    v_exp_f32 v181, -v201
    v_exp_f32 v178, v202
    v_exp_f32 v182, -v202
    v_exp_f32 v179, v203
    v_exp_f32 v183, -v203
    v_exp_f32 v184, v204
    v_exp_f32 v188, -v204
    v_exp_f32 v185, v205
    v_exp_f32 v189, -v205
    v_exp_f32 v186, v206
    v_exp_f32 v190, -v206
    v_exp_f32 v187, v207
    v_exp_f32 v191, -v207
    v_max3_f32 v13, abs(v192), abs(v193), abs(v194)
    v_max3_f32 v15, abs(v195), abs(v196), abs(v197)
    v_max3_f32 v13, v13, abs(v198), abs(v199)
    v_max3_f32 v15, v15, abs(v200), abs(v201)
    v_max3_f32 v13, v13, abs(v202), abs(v203)
    v_max3_f32 v15, v15, abs(v204), abs(v205)
    v_max3_f32 v13, v13, abs(v206), abs(v207)
    v_max_f32 v13, v13, v15
    v_cmp_nlt_f32 vcc, v13, s50
    s_cmp_lg_u64 vcc, 0
    s_cbranch_scc1 L_phs9
L_phj10:
    v_smfmac_f32_16x16x64_bf16 v[144:147], v[106:109], v[160:167], v10
    v_smfmac_f32_16x16x64_bf16 v[148:151], v[106:109], v[168:175], v10
    v_smfmac_f32_16x16x64_bf16 v[152:155], v[106:109], v[176:183], v10
    v_smfmac_f32_16x16x64_bf16 v[156:159], v[106:109], v[184:191], v10
    s_waitcnt vmcnt(0)
    v_cmp_gt_u32 vcc, 1, v4
    s_and_b32 s56, vcc_lo, 0x3f
    s_cbranch_scc1 L_qs16
L_qb17:
    buffer_load_dwordx4 v[208:211], v0, s[20:23], s63 offen sc1
    s_add_u32 s95, s63, 4096
    buffer_load_dwordx4 v[212:215], v0, s[20:23], s95 offen sc1
    v_rcp_f32 v144, v144
    v_rcp_f32 v145, v145
    buffer_load_dwordx4 v[2:5], v0, s[20:23], s34 offen sc1
    buffer_load_dwordx4 v[6:9], v0, s[20:23], s29 offen sc1
    v_rcp_f32 v148, v148
    v_rcp_f32 v149, v149
    s_add_u32 s95, s63, 8192
    buffer_load_dwordx4 v[216:219], v0, s[20:23], s95 offen sc1
    s_add_u32 s95, s63, 12288
    buffer_load_dwordx4 v[220:223], v0, s[20:23], s95 offen sc1
    v_rcp_f32 v152, v152
    v_rcp_f32 v153, v153
    v_rcp_f32 v156, v156
    v_rcp_f32 v157, v157
    v_mul_f32 v160, v160, v144
    v_mul_f32 v161, v161, v144
    v_mul_f32 v162, v162, v144
    v_mul_f32 v163, v163, v144
    v_mul_f32 v164, v164, v145
    v_mul_f32 v165, v165, v145
    v_mul_f32 v166, v166, v145
    v_mul_f32 v167, v167, v145
    v_cvt_pk_bf16_f32 v160, v160, v161
    v_cvt_pk_bf16_f32 v161, v162, v163
    v_cvt_pk_bf16_f32 v162, v164, v165
    v_cvt_pk_bf16_f32 v163, v166, v167
    v_mul_f32 v168, v168, v148
    v_mul_f32 v169, v169, v148
    v_mul_f32 v170, v170, v148
    v_mul_f32 v171, v171, v148
    v_mul_f32 v172, v172, v149
    v_mul_f32 v173, v173, v149
    v_mul_f32 v174, v174, v149
    v_mul_f32 v175, v175, v149
    v_cvt_pk_bf16_f32 v168, v168, v169
    v_cvt_pk_bf16_f32 v169, v170, v171
    s_waitcnt vmcnt(7)
    ds_read_b64_tr_b16 v[128:129], v125
    ds_read_b64_tr_b16 v[130:131], v125 offset:256
    v_cvt_pk_bf16_f32 v170, v172, v173
    v_cvt_pk_bf16_f32 v171, v174, v175
    v_mul_f32 v176, v176, v152
    v_mul_f32 v177, v177, v152
    v_mul_f32 v178, v178, v152
    v_mul_f32 v179, v179, v152
    v_mul_f32 v180, v180, v153
    v_mul_f32 v181, v181, v153
    v_mul_f32 v182, v182, v153
    v_mul_f32 v183, v183, v153
    v_cvt_pk_bf16_f32 v176, v176, v177
    v_cvt_pk_bf16_f32 v177, v178, v179
    v_cvt_pk_bf16_f32 v178, v180, v181
    v_cvt_pk_bf16_f32 v179, v182, v183
    v_mul_f32 v184, v184, v156
    v_mul_f32 v185, v185, v156
    v_mul_f32 v186, v186, v156
    v_mul_f32 v187, v187, v156
    v_mul_f32 v188, v188, v157
    v_mul_f32 v189, v189, v157
    v_mul_f32 v190, v190, v157
    v_mul_f32 v191, v191, v157
    v_cvt_pk_bf16_f32 v184, v184, v185
    v_cvt_pk_bf16_f32 v185, v186, v187
    v_cvt_pk_bf16_f32 v186, v188, v189
    v_cvt_pk_bf16_f32 v187, v190, v191
    v_mov_b32 v72, 0
    s_waitcnt vmcnt(5)
    ds_write_b128 v114, v[208:211] offset:0
    s_waitcnt vmcnt(4)
    ds_write_b128 v114, v[212:215] offset:9216
    s_waitcnt lgkmcnt(0)
    s_barrier
    s_setprio 3
    ds_read_b128 v[96:99], v112
    ds_read_b128 v[100:103], v113
    s_waitcnt vmcnt(2) lgkmcnt(0)
    v_mfma_f32_32x32x16_bf16 v[32:47], v[96:99], v[2:5], 0
    v_mov_b32 v80, 0
    v_mov_b32 v81, 0
    v_mov_b32 v82, 0
    v_mov_b32 v83, 0
    v_mov_b32 v84, 0
    v_mov_b32 v85, 0
    v_mov_b32 v86, 0
    v_mov_b32 v87, 0
    v_mov_b32 v88, 0
    v_and_b32 v13, 0x60, v121
    v_and_b32 v121, 0x1c, v121
    v_lshl_or_b32 v121, v13, 2, v121
    v_exp_f32 v32, v32
    v_exp_f32 v33, v33
    v_exp_f32 v34, v34
    v_exp_f32 v35, v35
    v_mfma_f32_32x32x16_bf16 v[48:63], v[96:99], v[6:9], 0
    v_exp_f32 v36, v36
    ds_read_b128 v[108:111], v113 offset:256
    ds_read_b128 v[96:99], v112 offset:4608
    ds_read_b128 v[104:107], v113 offset:4608
    v_exp_f32 v37, v37
    buffer_store_dwordx4 v[160:163], v0, s[20:23], s52 offen offset:0 sc1
    v_exp_f32 v38, v38
    v_exp_f32 v39, v39
    v_exp_f32 v40, v40
    v_exp_f32 v41, v41
    v_exp_f32 v42, v42
    v_exp_f32 v43, v43
    v_smfmac_f32_32x32x32_bf16 v[64:79], v[100:103], v[32:39], v10
    v_exp_f32 v44, v44
    v_exp_f32 v45, v45
    v_exp_f32 v46, v46
    v_exp_f32 v47, v47
    v_exp_f32 v48, v48
    v_exp_f32 v49, v49
    s_waitcnt lgkmcnt(0)
    v_smfmac_f32_32x32x32_bf16 v[64:79], v[108:111], v[40:47], v10
    v_exp_f32 v50, v50
    v_exp_f32 v51, v51
    v_mfma_f32_32x32x16_bf16 v[32:47], v[96:99], v[2:5], 0
    v_exp_f32 v52, v52
    v_exp_f32 v53, v53
    buffer_store_dwordx4 v[168:171], v0, s[20:23], s52 offen offset:1024 sc1
    v_exp_f32 v54, v54
    v_exp_f32 v55, v55
    v_exp_f32 v56, v56
    v_exp_f32 v57, v57
    v_exp_f32 v58, v58
    v_exp_f32 v59, v59
    v_smfmac_f32_32x32x32_bf16 v[80:95], v[100:103], v[48:55], v10
    v_exp_f32 v60, v60
    v_exp_f32 v61, v61
    v_exp_f32 v62, v62
    v_exp_f32 v63, v63
    v_exp_f32 v32, v32
    v_exp_f32 v33, v33
    v_smfmac_f32_32x32x32_bf16 v[80:95], v[108:111], v[56:63], v10
    v_exp_f32 v34, v34
    v_exp_f32 v35, v35
    v_mfma_f32_32x32x16_bf16 v[48:63], v[96:99], v[6:9], 0
    v_exp_f32 v36, v36
    ds_read_b128 v[108:111], v113 offset:4864
    ds_read_b128 v[96:99], v112 offset:9216
    ds_read_b128 v[100:103], v113 offset:9216
    v_exp_f32 v37, v37
    s_add_u32 s52, s52, 131072
    buffer_store_dwordx4 v[176:179], v0, s[20:23], s52 offen offset:0 sc1
    v_exp_f32 v38, v38
    v_exp_f32 v39, v39
    v_exp_f32 v40, v40
    v_exp_f32 v41, v41
    v_exp_f32 v42, v42
    v_exp_f32 v43, v43
    v_smfmac_f32_32x32x32_bf16 v[64:79], v[104:107], v[32:39], v10
    v_exp_f32 v44, v44
    v_exp_f32 v45, v45
    v_exp_f32 v46, v46
    v_exp_f32 v47, v47
    v_exp_f32 v48, v48
    v_exp_f32 v49, v49
    s_waitcnt lgkmcnt(0)
    v_smfmac_f32_32x32x32_bf16 v[64:79], v[108:111], v[40:47], v10
    v_exp_f32 v50, v50
    v_exp_f32 v51, v51
    v_mfma_f32_32x32x16_bf16 v[32:47], v[96:99], v[2:5], 0
    v_exp_f32 v52, v52
    v_exp_f32 v53, v53
    s_mov_b64 exec, 0xf00
    buffer_load_dword v11, v127, s[20:23], 0 offen sc1
    s_mov_b64 exec, -1
    s_setprio 2
    v_exp_f32 v54, v54
    v_exp_f32 v55, v55
    v_exp_f32 v56, v56
    buffer_store_dwordx4 v[184:187], v0, s[20:23], s52 offen offset:1024 sc1
    v_exp_f32 v57, v57
    v_exp_f32 v58, v58
    v_exp_f32 v59, v59
    v_smfmac_f32_32x32x32_bf16 v[80:95], v[104:107], v[48:55], v10
    v_exp_f32 v60, v60
    v_exp_f32 v61, v61
    v_exp_f32 v62, v62
    v_exp_f32 v63, v63
    v_exp_f32 v32, v32
    v_exp_f32 v33, v33
    v_smfmac_f32_32x32x32_bf16 v[80:95], v[108:111], v[56:63], v10
    v_exp_f32 v34, v34
    v_exp_f32 v35, v35
    v_mfma_f32_32x32x16_bf16 v[48:63], v[96:99], v[6:9], 0
    v_exp_f32 v36, v36
    ds_read_b128 v[108:111], v113 offset:9472
    ds_read_b128 v[96:99], v112 offset:13824
    ds_read_b128 v[104:107], v113 offset:13824
    v_exp_f32 v37, v37
    s_waitcnt vmcnt(6)
    ds_write_b128 v114, v[216:219] offset:18432
    v_exp_f32 v38, v38
    v_exp_f32 v39, v39
    v_exp_f32 v40, v40
    v_exp_f32 v41, v41
    v_exp_f32 v42, v42
    v_exp_f32 v43, v43
    v_smfmac_f32_32x32x32_bf16 v[64:79], v[100:103], v[32:39], v10
    v_exp_f32 v44, v44
    v_exp_f32 v45, v45
    v_exp_f32 v46, v46
    s_setprio 1
    v_exp_f32 v47, v47
    v_exp_f32 v48, v48
    v_exp_f32 v49, v49
    s_waitcnt lgkmcnt(0)
    v_smfmac_f32_32x32x32_bf16 v[64:79], v[108:111], v[40:47], v10
    v_exp_f32 v50, v50
    v_exp_f32 v51, v51
    v_mfma_f32_32x32x16_bf16 v[32:47], v[96:99], v[2:5], 0
    v_exp_f32 v52, v52
    v_exp_f32 v53, v53
    s_waitcnt vmcnt(5)
    ds_write_b128 v114, v[220:223] offset:27648
    v_exp_f32 v54, v54
    v_exp_f32 v55, v55
    v_exp_f32 v56, v56
    buffer_store_dwordx4 v[128:131], v126, s[20:23], s99 offen sc1
    v_exp_f32 v57, v57
    v_exp_f32 v58, v58
    v_exp_f32 v59, v59
    v_smfmac_f32_32x32x32_bf16 v[80:95], v[100:103], v[48:55], v10
    s_setprio 0
    v_exp_f32 v60, v60
    v_exp_f32 v61, v61
    v_exp_f32 v62, v62
    v_exp_f32 v63, v63
    v_exp_f32 v32, v32
    v_exp_f32 v33, v33
    v_smfmac_f32_32x32x32_bf16 v[80:95], v[108:111], v[56:63], v10
    v_exp_f32 v34, v34
    s_waitcnt lgkmcnt(0)
    s_barrier
    s_setprio 3
    v_exp_f32 v35, v35
    v_mfma_f32_32x32x16_bf16 v[48:63], v[96:99], v[6:9], 0
    v_exp_f32 v36, v36
    ds_read_b128 v[108:111], v113 offset:14080
    ds_read_b128 v[96:99], v112 offset:18432
    ds_read_b128 v[100:103], v113 offset:18432
    v_exp_f32 v37, v37
    v_exp_f32 v38, v38
    v_exp_f32 v39, v39
    v_exp_f32 v40, v40
    v_exp_f32 v41, v41
    v_exp_f32 v42, v42
    v_exp_f32 v43, v43
    v_smfmac_f32_32x32x32_bf16 v[64:79], v[104:107], v[32:39], v10
    v_exp_f32 v44, v44
    v_exp_f32 v45, v45
    v_exp_f32 v46, v46
    v_exp_f32 v47, v47
    v_exp_f32 v48, v48
    v_exp_f32 v49, v49
    s_waitcnt lgkmcnt(0)
    v_smfmac_f32_32x32x32_bf16 v[64:79], v[108:111], v[40:47], v10
    v_exp_f32 v50, v50
    v_exp_f32 v51, v51
    v_mfma_f32_32x32x16_bf16 v[32:47], v[96:99], v[2:5], 0
    v_exp_f32 v52, v52
    v_exp_f32 v53, v53
    s_waitcnt vmcnt(2)
    v_cmp_gt_u32 vcc, 1, v11
    s_and_b32 s56, vcc_lo, 0xf00
    s_cbranch_scc1 L_qs19
L_qb20:
    v_exp_f32 v54, v54
    v_exp_f32 v55, v55
    v_exp_f32 v56, v56
    s_add_u32 s95, s63, 16384
    buffer_load_dwordx4 v[16:19], v0, s[20:23], s95 offen sc1
    v_exp_f32 v57, v57
    v_exp_f32 v58, v58
    v_exp_f32 v59, v59
    v_smfmac_f32_32x32x32_bf16 v[80:95], v[104:107], v[48:55], v10
    v_exp_f32 v60, v60
    v_exp_f32 v61, v61
    v_exp_f32 v62, v62
    v_exp_f32 v63, v63
    v_exp_f32 v32, v32
    v_exp_f32 v33, v33
    v_smfmac_f32_32x32x32_bf16 v[80:95], v[108:111], v[56:63], v10
    v_exp_f32 v34, v34
    v_exp_f32 v35, v35
    v_mfma_f32_32x32x16_bf16 v[48:63], v[96:99], v[6:9], 0
    v_exp_f32 v36, v36
    ds_read_b128 v[108:111], v113 offset:18688
    ds_read_b128 v[96:99], v112 offset:23040
    ds_read_b128 v[104:107], v113 offset:23040
    v_exp_f32 v37, v37
    s_add_u32 s95, s63, 20480
    buffer_load_dwordx4 v[20:23], v0, s[20:23], s95 offen sc1
    v_exp_f32 v38, v38
    v_exp_f32 v39, v39
    v_exp_f32 v40, v40
    v_exp_f32 v41, v41
    v_exp_f32 v42, v42
    v_exp_f32 v43, v43
    v_smfmac_f32_32x32x32_bf16 v[64:79], v[100:103], v[32:39], v10
    v_exp_f32 v44, v44
    v_exp_f32 v45, v45
    v_exp_f32 v46, v46
    v_exp_f32 v47, v47
    v_exp_f32 v48, v48
    v_exp_f32 v49, v49
    s_waitcnt lgkmcnt(0)
    v_smfmac_f32_32x32x32_bf16 v[64:79], v[108:111], v[40:47], v10
    v_exp_f32 v50, v50
    v_exp_f32 v51, v51
    v_mfma_f32_32x32x16_bf16 v[32:47], v[96:99], v[2:5], 0
    v_exp_f32 v52, v52
    v_exp_f32 v53, v53
    v_exp_f32 v54, v54
    v_exp_f32 v55, v55
    v_exp_f32 v56, v56
    v_exp_f32 v57, v57
    v_exp_f32 v58, v58
    v_exp_f32 v59, v59
    v_smfmac_f32_32x32x32_bf16 v[80:95], v[100:103], v[48:55], v10
    v_exp_f32 v60, v60
    v_exp_f32 v61, v61
    v_exp_f32 v62, v62
    v_exp_f32 v63, v63
    v_exp_f32 v32, v32
    v_exp_f32 v33, v33
    v_smfmac_f32_32x32x32_bf16 v[80:95], v[108:111], v[56:63], v10
    v_exp_f32 v34, v34
    s_waitcnt vmcnt(2) lgkmcnt(0)
    s_barrier
    s_cmp_lg_u32 s31, 0
    s_cbranch_scc1 L_w0_22
    s_lshl_b32 s56, s36, 8
    s_add_u32 s56, s56, 17829888
    v_mov_b32 v15, 0
    v_mov_b32 v13, 1
    s_mov_b64 exec, 1
    buffer_atomic_add v13, v15, s[20:23], s56 offen sc1
    s_mov_b64 exec, -1
L_w0_22:
    v_exp_f32 v35, v35
    v_mfma_f32_32x32x16_bf16 v[48:63], v[96:99], v[6:9], 0
    v_exp_f32 v36, v36
    ds_read_b128 v[108:111], v113 offset:23296
    ds_read_b128 v[96:99], v112 offset:27648
    ds_read_b128 v[100:103], v113 offset:27648
    v_exp_f32 v37, v37
    s_add_u32 s95, s63, 24576
    buffer_load_dwordx4 v[24:27], v0, s[20:23], s95 offen sc1
    v_exp_f32 v38, v38
    v_exp_f32 v39, v39
    v_exp_f32 v40, v40
    s_setprio 2
    v_exp_f32 v41, v41
    v_exp_f32 v42, v42
    v_exp_f32 v43, v43
    v_smfmac_f32_32x32x32_bf16 v[64:79], v[104:107], v[32:39], v10
    v_exp_f32 v44, v44
    v_exp_f32 v45, v45
    v_exp_f32 v46, v46
    v_exp_f32 v47, v47
    s_branch L_att
L_ty1:
    s_add_u32 m0, s46, 65536
    s_mov_b32 s16, s72
    s_mov_b32 s17, s73
    buffer_load_dwordx4 v4, s[12:15], s37 offen offset:0 lds
    s_mov_b32 s18, 0x180000
    s_mov_b32 s19, 0x20000
    buffer_load_dwordx4 v4, s[16:19], s37 offen offset:1024 lds
    s_add_u32 s35, s43, 1
    s_and_b32 s35, s35, 7
    s_lshl_b32 s64, s35, 7
    s_add_u32 s64, s64, s38
    s_mul_i32 s65, s35, 196608
    s_add_u32 s65, s65, s42
    s_barrier
    s_add_u32 m0, s46, 16384
    s_nop 0
    buffer_load_dwordx4 v2, s[8:11], s64 offen lds
    buffer_load_dwordx4 v3, s[8:11], s64 offen offset:1024 lds
    s_and_b32 s32, s31, 3
    s_lshr_b32 s33, s31, 2
    s_mov_b32 s24, s74
    s_mov_b32 s25, s75
    s_mov_b32 s26, 0x4000
    s_mov_b32 s27, 0x20000
    s_mov_b32 s88, s78
    s_mov_b32 s89, s79
    s_mov_b32 s90, 0x400
    s_mov_b32 s91, 0x20000
    v_lshlrev_b32 v0, 4, v1
    s_lshl_b32 s44, s44, 1
    s_add_u32 s44, s44, s33
    s_lshl_b32 s56, s44, 10
    s_lshl_b32 s96, s30, 4
    s_add_u32 s96, s96, s28
    s_lshl_b32 s96, s96, 3
    s_add_u32 s96, s96, s31
    s_lshl_b32 s57, s96, 10
    s_add_u32 s35, s43, 2
    s_and_b32 s35, s35, 7
    s_lshl_b32 s66, s35, 7
    s_add_u32 s66, s66, s38
    s_mul_i32 s67, s35, 196608
    s_add_u32 s67, s67, s42
    s_mov_b32 s20, s84
    s_mov_b32 s21, s85
    s_mov_b32 s22, 0x1300000
    s_mov_b32 s23, 0x20000
    s_add_u32 s35, s43, 3
    s_and_b32 s35, s35, 7
    s_lshl_b32 s70, s35, 7
    s_add_u32 s70, s70, s38
    s_mul_i32 s71, s35, 196608
    s_add_u32 s71, s71, s42
    v_and_b32 v12, 15, v1
    v_lshlrev_b32 v5, 7, v12
    v_lshrrev_b32 v15, 1, v12
    v_xor_b32 v15, v15, v13
    v_lshl_add_u32 v5, v15, 4, v5
    s_lshl_b32 s35, s32, 12
    v_add_u32 v5, s35, v5
    v_xor_b32 v6, 64, v5
    v_and_b32 v15, 24, v1
    s_lshl_b32 s35, s33, 4
    v_xor_b32 v15, s35, v15
    v_and_b32 v9, 12, v1
    v_lshlrev_b32 v9, 5, v9
    v_lshl_add_u32 v9, v15, 2, v9
    v_and_b32 v15, 3, v1
    v_lshl_add_u32 v9, v15, 3, v9
    v_lshl_add_u32 v9, v13, 11, v9
    v_add_u32 v7, 0x10000, v9
    v_xor_b32 v8, 32, v7
    v_add_u32 v9, 0x20000, v9
    v_xor_b32 v11, 32, v9
    s_lshl_b32 s51, s30, 2
    s_add_u32 s51, s51, s32
    s_lshl_b32 s52, s44, 7
    s_add_u32 s52, s52, s51
    s_lshl_b32 s53, s52, 10
    s_lshl_b32 s39, s36, 2
    s_add_u32 s39, s39, s41
    s_lshl_b32 s45, s40, 3
    s_lshl_b32 s92, s32, 1
    s_add_u32 s62, s45, s92
    s_add_u32 s62, s62, s33
    s_add_u32 s45, s45, s31
    s_lshl_b32 s97, s62, 6
    s_add_u32 s97, s97, s39
    s_lshl_b32 s97, s97, 10
    s_add_u32 s97, s97, 13631488
    s_mov_b32 s4, s82
    s_mov_b32 s5, s83
    s_mov_b32 s6, 0x100
    s_mov_b32 s7, 0x20000
    s_add_u32 s35, s43, 4
    s_and_b32 s35, s35, 7
    s_lshl_b32 s72, s35, 7
    s_add_u32 s72, s72, s38
    s_mul_i32 s73, s35, 196608
    s_add_u32 s73, s73, s42
    s_add_u32 s35, s43, 5
    s_and_b32 s35, s35, 7
    s_lshl_b32 s74, s35, 7
    s_add_u32 s74, s74, s38
    s_mul_i32 s75, s35, 196608
    s_add_u32 s75, s75, s42
    s_add_u32 s35, s43, 6
    s_and_b32 s35, s35, 7
    s_lshl_b32 s78, s35, 7
    s_add_u32 s78, s78, s38
    s_mul_i32 s79, s35, 196608
    s_add_u32 s79, s79, s42
    s_add_u32 s35, s43, 7
    s_and_b32 s35, s35, 7
    s_lshl_b32 s68, s35, 7
    s_add_u32 s68, s68, s38
    s_mul_i32 s69, s35, 196608
    s_add_u32 s69, s69, s42
    s_mov_b32 s42, s2
    s_lshr_b32 s96, s96, 3
    s_lshl_b32 s96, s96, 7
    s_add_u32 s96, s96, 12582912
    v_mov_b32 v96, 0
    v_mov_b32 v97, 0
    v_mov_b32 v100, 0
    v_mov_b32 v101, 0
    v_mov_b32 v104, 0
    v_mov_b32 v105, 0
    v_and_b32 v13, 3, v1
    v_lshlrev_b32 v13, 4, v13
    v_mov_b32 v106, 0x3f80
    v_mov_b32 v107, 0
    v_lshlrev_b64 v[106:107], v13, v[106:107]
    v_bfe_u32 v13, v1, 2, 2
    v_lshrrev_b32 v15, 4, v1
    v_cmp_eq_u32 s[58:59], v13, v15
    v_mov_b32 v108, 0
    s_add_u32 m0, s46, 81920
    s_nop 0
    buffer_load_dwordx4 v4, s[12:15], s65 offen offset:0 lds
    v_mov_b32 v109, 0
    v_cndmask_b32 v106, 0, v106, s[58:59]
    v_cndmask_b32 v107, 0, v107, s[58:59]
    v_mov_b32 v10, 0xdddddddd
    s_lshl_b32 s92, s33, 10
    v_add_u32 v112, s92, v0
    buffer_load_dwordx4 v4, s[16:19], s65 offen offset:1024 lds
    v_and_b32 v13, 0x230, v0
    v_and_b32 v15, 0x40, v0
    v_lshl_add_u32 v13, v15, 1, v13
    v_and_b32 v15, 0x80, v0
    v_lshrrev_b32 v15, 1, v15
    s_lshl_b32 s92, s33, 10
    s_add_u32 s92, s92, 2048
    v_add3_u32 v113, v13, v15, s92
    buffer_load_dwordx4 v[252:255], v0, s[88:91], 0 offen
    v_and_b32 v117, 0xf0, v0
    v_add_u32 v13, 4096, v117
    s_mov_b32 s60, 0x0000ffff
    s_mov_b32 s61, 0x0000ffff
    buffer_load_dwordx4 v[248:251], v0, s[8:11], s57 offen
    v_cndmask_b32 v113, v13, v113, s[60:61]
    s_lshr_b32 s92, s32, 1
    s_mul_i32 s92, s92, 4608
    s_and_b32 s93, s31, 1
    s_lshl_b32 s93, s93, 10
    s_add_u32 s92, s92, s93
    s_lshl_b32 s93, s33, 11
    s_add_u32 s92, s92, s93
    v_add_u32 v114, s92, v0
    buffer_load_dwordx4 v[240:243], v0, s[24:27], s56 offen
    s_lshl_b32 s92, s31, 12
    s_add_u32 s92, s92, 65536
    v_add_u32 v115, s92, v0
    v_add_u32 v116, 98304, v0
    s_lshl_b32 s92, s33, 14
    s_lshl_b32 s93, s32, 10
    s_add_u32 s92, s92, s93
    s_add_u32 s92, s92, 65536
    v_add_u32 v124, s92, v0
    v_lshrrev_b32 v15, 4, v1
    v_lshl_add_u32 v123, v15, 9, v117
    v_lshl_add_u32 v119, v15, 1, v117
    s_lshl_b32 s92, s32, 8
    s_lshl_b32 s93, s33, 3
    s_add_u32 s92, s92, s93
    s_add_u32 s92, s92, 98304
    v_add_u32 v119, s92, v119
    v_lshlrev_b32 v118, 8, v117
    v_lshl_add_u32 v118, v15, 2, v118
    v_lshl_add_u32 v117, v15, 12, v117
    v_and_b32 v13, 7, v1
    v_lshlrev_b32 v120, 8, v13
    v_and_b32 v13, 31, v1
    v_lshlrev_b32 v121, 2, v13
    s_lshl_b32 s63, s39, 16
    s_lshl_b32 s92, s32, 10
    s_add_u32 s63, s63, s92
    s_lshl_b32 s92, s33, 21
    s_add_u32 s63, s63, s92
    s_add_u32 s63, s63, 2097152
    s_lshl_b32 s98, s41, 3
    s_add_u32 s98, s98, s31
    s_lshl_b32 s98, s98, 14
    s_add_u32 s98, s98, 18874368
    s_lshl_b32 s100, s36, 3
    s_add_u32 s100, s100, s40
    s_lshl_b32 s101, s100, 16
    s_lshl_b32 s93, s31, 12
    s_add_u32 s101, s101, s93
    s_add_u32 s101, s101, 13631488
    v_lshrrev_b32 v13, 5, v1
    v_mul_u32_u24 v13, 4096, v13
    s_min_u32 s92, s31, 5
    s_mul_i32 s92, s92, 9216
    s_add_u32 s92, s92, 4096
    v_add3_u32 v12, v13, v0, s92
    v_and_b32 v13, 11, v1
    v_cmp_eq_u32 s[58:59], 0, v13
    v_mov_b32 v13, 0x3f803f80
    s_mov_b32 s48, 0x3fb8aa3b
    v_cndmask_b32 v122, 0, v13, s[58:59]
    s_lshl_b32 s76, s36, 9
    s_add_u32 s76, s76, 17825792
    s_lshr_b32 s92, s40, 1
    s_lshl_b32 s92, s92, 7
    s_and_b32 s93, s40, 1
    s_lshl_b32 s93, s93, 3
    s_add_u32 s92, s92, s93
    s_add_u32 s92, s92, s76
    s_add_u32 s76, s76, 4224
    s_add_u32 s93, s92, 4
    v_lshl_add_u32 v127, v1, 2, s76
    v_writelane_b32 v127, s92, 4
    v_writelane_b32 v127, s93, 5
    s_add_u32 s76, s76, 256
    v_writelane_b32 v127, s76, 6
    v_and_b32 v13, 8, v1
    v_mad_u32_u24 v127, v13, 28, v127
    s_lshr_b32 s77, s28, 1
    s_lshl_b32 s77, s77, 9
    s_lshr_b32 s92, s30, 2
    s_lshl_b32 s92, s92, 7
    s_and_b32 s93, s30, 3
    s_lshl_b32 s93, s93, 2
    s_add_u32 s77, s77, s92
    s_add_u32 s77, s77, s93
    s_add_u32 s77, s77, 17825792
    s_lshl_b32 s38, s45, 6
    s_add_u32 s38, s38, s39
    s_lshl_b32 s38, s38, 10
    s_add_u32 s38, s38, 13664256
    s_mov_b32 s24, s80
    s_mov_b32 s25, s81
    s_mov_b32 s26, 0x200000
    s_mov_b32 s49, 0x3eb8aa3b
    s_mov_b32 s50, 0x42700000
    s_lshl_b32 s88, s39, 16
    s_add_u32 s88, s88, 10485760
    s_lshl_b32 s93, s31, 8
    s_add_u32 s88, s88, s93
    s_mov_b32 s89, s88
    s_lshl_b32 s90, s39, 6
    s_add_u32 s93, s90, s62
    s_add_u32 s90, s90, s45
    s_lshl_b32 s90, s90, 11
    s_add_u32 s90, s90, 6291456
    s_lshl_b32 s29, s93, 10
    s_lshl_b32 s91, s62, 9
    s_add_u32 s91, s91, 12582912
    s_xor_b32 s34, s29, 1024
    s_waitcnt vmcnt(7)
    s_barrier
    ds_read_b128 v[128:131], v5 offset:0
    ds_read_b128 v[132:135], v5 offset:2048
    ds_read_b64_tr_b16 v[64:65], v7 offset:0
    ds_read_b64_tr_b16 v[66:67], v7 offset:512
    ds_read_b64_tr_b16 v[68:69], v8 offset:0
    ds_read_b64_tr_b16 v[70:71], v8 offset:512
    ds_read_b128 v[136:139], v6 offset:0
    ds_read_b128 v[140:143], v6 offset:2048
    ds_read_b64_tr_b16 v[72:73], v7 offset:1024
    ds_read_b64_tr_b16 v[74:75], v7 offset:1536
    ds_read_b64_tr_b16 v[76:77], v8 offset:1024
    ds_read_b64_tr_b16 v[78:79], v8 offset:1536
    ds_read_b64_tr_b16 v[80:81], v7 offset:8192
    ds_read_b64_tr_b16 v[82:83], v7 offset:8704
    ds_read_b64_tr_b16 v[84:85], v8 offset:8192
    ds_read_b64_tr_b16 v[86:87], v8 offset:8704
    ds_read_b64_tr_b16 v[88:89], v7 offset:9216
    ds_read_b64_tr_b16 v[90:91], v7 offset:9728
    ds_read_b64_tr_b16 v[92:93], v8 offset:9216
    ds_read_b64_tr_b16 v[94:95], v8 offset:9728
    s_add_u32 m0, s46, 32768
    s_nop 0
    buffer_load_dwordx4 v2, s[8:11], s66 offen lds
    buffer_load_dwordx4 v3, s[8:11], s66 offen offset:1024 lds
    s_add_u32 m0, s46, 98304
    s_nop 0
    buffer_load_dwordx4 v4, s[12:15], s67 offen offset:0 lds
    buffer_load_dwordx4 v4, s[16:19], s67 offen offset:1024 lds
    s_waitcnt vmcnt(7) lgkmcnt(12)
    s_barrier
    s_add_u32 m0, s46, 49152
    v_mfma_f32_16x16x32_bf16 v[48:51], v[64:67], v[128:131], 0
    ds_read_b128 v[144:147], v5 offset:16384
    buffer_load_dwordx4 v2, s[8:11], s70 offen lds
    v_mfma_f32_16x16x32_bf16 v[52:55], v[64:67], v[132:135], 0
    ds_read_b64_tr_b16 v[64:65], v7 offset:16384
    ds_read_b64_tr_b16 v[66:67], v7 offset:16896
    v_mfma_f32_16x16x32_bf16 v[56:59], v[68:71], v[128:131], 0
    ds_read_b128 v[148:151], v5 offset:18432
    s_lshl_b32 s92, s44, 7
    s_add_u32 s51, s51, s92
    s_lshl_b32 s51, s51, 10
    s_add_u32 s51, s51, 10485760
    v_mfma_f32_16x16x32_bf16 v[60:63], v[68:71], v[132:135], 0
    ds_read_b64_tr_b16 v[68:69], v8 offset:16384
    ds_read_b64_tr_b16 v[70:71], v8 offset:16896
    buffer_load_dwordx4 v3, s[8:11], s70 offen offset:1024 lds
    s_waitcnt lgkmcnt(14)
    v_mfma_f32_16x16x32_bf16 v[16:19], v[72:75], v[128:131], 0
    ds_read_b128 v[152:155], v6 offset:16384
    v_mfma_f32_16x16x32_bf16 v[20:23], v[72:75], v[132:135], 0
    ds_read_b64_tr_b16 v[72:73], v7 offset:17408
    ds_read_b64_tr_b16 v[74:75], v7 offset:17920
    v_mov_b32 v244, 0
    s_add_u32 m0, s46, 114688
    v_mfma_f32_16x16x32_bf16 v[24:27], v[76:79], v[128:131], 0
    ds_read_b128 v[156:159], v6 offset:18432
    buffer_load_dwordx4 v4, s[12:15], s71 offen offset:0 lds
    v_mfma_f32_16x16x32_bf16 v[28:31], v[76:79], v[132:135], 0
    ds_read_b64_tr_b16 v[76:77], v8 offset:17408
    ds_read_b64_tr_b16 v[78:79], v8 offset:17920
    v_add_u32 v110, s47, v0
    v_lshl_add_u32 v111, v1, 3, s47
    s_waitcnt lgkmcnt(15)
    v_mfma_f32_16x16x32_bf16 v[48:51], v[80:83], v[136:139], v[48:51]
    v_mfma_f32_16x16x32_bf16 v[52:55], v[80:83], v[140:143], v[52:55]
    ds_read_b64_tr_b16 v[80:81], v7 offset:24576
    ds_read_b64_tr_b16 v[82:83], v7 offset:25088
    buffer_load_dwordx4 v4, s[16:19], s71 offen offset:1024 lds
    v_mfma_f32_16x16x32_bf16 v[56:59], v[84:87], v[136:139], v[56:59]
    v_mfma_f32_16x16x32_bf16 v[60:63], v[84:87], v[140:143], v[60:63]
    ds_read_b64_tr_b16 v[84:85], v8 offset:24576
    ds_read_b64_tr_b16 v[86:87], v8 offset:25088
    s_waitcnt lgkmcnt(15)
    s_add_u32 m0, s46, 0
    v_mfma_f32_16x16x32_bf16 v[16:19], v[88:91], v[136:139], v[16:19]
    buffer_load_dwordx4 v2, s[8:11], s72 offen lds
    v_mfma_f32_16x16x32_bf16 v[20:23], v[88:91], v[140:143], v[20:23]
    ds_read_b64_tr_b16 v[88:89], v7 offset:25600
    ds_read_b64_tr_b16 v[90:91], v7 offset:26112
    v_mfma_f32_16x16x32_bf16 v[24:27], v[92:95], v[136:139], v[24:27]
    v_mfma_f32_16x16x32_bf16 v[28:31], v[92:95], v[140:143], v[28:31]
    ds_read_b64_tr_b16 v[92:93], v8 offset:25600
    ds_read_b64_tr_b16 v[94:95], v8 offset:26112
    buffer_load_dwordx4 v3, s[8:11], s72 offen offset:1024 lds
    s_add_u32 m0, s46, 131072
    s_nop 0
    buffer_load_dwordx4 v4, s[12:15], s73 offen offset:0 lds
    buffer_load_dwordx4 v4, s[16:19], s73 offen offset:1024 lds
    s_waitcnt vmcnt(8) lgkmcnt(8)
    s_barrier
    s_add_u32 m0, s46, 16384
    v_mfma_f32_16x16x32_bf16 v[48:51], v[64:67], v[144:147], v[48:51]
    ds_read_b128 v[160:163], v5 offset:32768
    buffer_load_dwordx4 v2, s[8:11], s74 offen lds
    v_mfma_f32_16x16x32_bf16 v[52:55], v[64:67], v[148:151], v[52:55]
    ds_read_b64_tr_b16 v[64:65], v7 offset:32768
    ds_read_b64_tr_b16 v[66:67], v7 offset:33280
    v_mfma_f32_16x16x32_bf16 v[56:59], v[68:71], v[144:147], v[56:59]
    ds_read_b128 v[164:167], v5 offset:34816
    v_mfma_f32_16x16x32_bf16 v[60:63], v[68:71], v[148:151], v[60:63]
    ds_read_b64_tr_b16 v[68:69], v8 offset:32768
    ds_read_b64_tr_b16 v[70:71], v8 offset:33280
    buffer_load_dwordx4 v3, s[8:11], s74 offen offset:1024 lds
    v_mfma_f32_16x16x32_bf16 v[16:19], v[72:75], v[144:147], v[16:19]
    ds_read_b128 v[168:171], v6 offset:32768
    v_mfma_f32_16x16x32_bf16 v[20:23], v[72:75], v[148:151], v[20:23]
    ds_read_b64_tr_b16 v[72:73], v7 offset:33792
    ds_read_b64_tr_b16 v[74:75], v7 offset:34304
    s_add_u32 m0, s46, 147456
    v_mfma_f32_16x16x32_bf16 v[24:27], v[76:79], v[144:147], v[24:27]
    ds_read_b128 v[172:175], v6 offset:34816
    buffer_load_dwordx4 v4, s[12:15], s75 offen offset:0 lds
    v_mfma_f32_16x16x32_bf16 v[28:31], v[76:79], v[148:151], v[28:31]
    ds_read_b64_tr_b16 v[76:77], v8 offset:33792
    ds_read_b64_tr_b16 v[78:79], v8 offset:34304
    s_waitcnt lgkmcnt(12)
    v_mfma_f32_16x16x32_bf16 v[48:51], v[80:83], v[152:155], v[48:51]
    v_mfma_f32_16x16x32_bf16 v[52:55], v[80:83], v[156:159], v[52:55]
    ds_read_b64_tr_b16 v[80:81], v7 offset:40960
    ds_read_b64_tr_b16 v[82:83], v7 offset:41472
    buffer_load_dwordx4 v4, s[16:19], s75 offen offset:1024 lds
    v_mfma_f32_16x16x32_bf16 v[56:59], v[84:87], v[152:155], v[56:59]
    v_mfma_f32_16x16x32_bf16 v[60:63], v[84:87], v[156:159], v[60:63]
    ds_read_b64_tr_b16 v[84:85], v8 offset:40960
    ds_read_b64_tr_b16 v[86:87], v8 offset:41472
    v_mfma_f32_16x16x32_bf16 v[16:19], v[88:91], v[152:155], v[16:19]
    v_mfma_f32_16x16x32_bf16 v[20:23], v[88:91], v[156:159], v[20:23]
    ds_read_b64_tr_b16 v[88:89], v7 offset:41984
    ds_read_b64_tr_b16 v[90:91], v7 offset:42496
    v_mfma_f32_16x16x32_bf16 v[24:27], v[92:95], v[152:155], v[24:27]
    v_mfma_f32_16x16x32_bf16 v[28:31], v[92:95], v[156:159], v[28:31]
    ds_read_b64_tr_b16 v[92:93], v8 offset:41984
    ds_read_b64_tr_b16 v[94:95], v8 offset:42496
    s_waitcnt vmcnt(8) lgkmcnt(8)
    s_barrier
    s_add_u32 m0, s46, 32768
    v_mfma_f32_16x16x32_bf16 v[48:51], v[64:67], v[160:163], v[48:51]
    ds_read_b128 v[176:179], v5 offset:49152
    buffer_load_dwordx4 v2, s[8:11], s78 offen lds
    v_mfma_f32_16x16x32_bf16 v[52:55], v[64:67], v[164:167], v[52:55]
    ds_read_b64_tr_b16 v[64:65], v7 offset:49152
    ds_read_b64_tr_b16 v[66:67], v7 offset:49664
    s_waitcnt vmcnt(17)
    v_dot2c_f32_bf16 v244, v248, v252
    v_dot2c_f32_bf16 v244, v249, v253
    v_mfma_f32_16x16x32_bf16 v[56:59], v[68:71], v[160:163], v[56:59]
    ds_read_b128 v[180:183], v5 offset:51200
    v_dot2c_f32_bf16 v244, v250, v254
    v_dot2c_f32_bf16 v244, v251, v255
    v_mfma_f32_16x16x32_bf16 v[60:63], v[68:71], v[164:167], v[60:63]
    ds_read_b64_tr_b16 v[68:69], v8 offset:49152
    ds_read_b64_tr_b16 v[70:71], v8 offset:49664
    buffer_load_dwordx4 v3, s[8:11], s78 offen offset:1024 lds
    v_mfma_f32_16x16x32_bf16 v[16:19], v[72:75], v[160:163], v[16:19]
    ds_read_b128 v[184:187], v6 offset:49152
    v_add_f32_dpp v244, v244, v244 quad_perm:[1,0,3,2] row_mask:0xf bank_mask:0xf
    v_mfma_f32_16x16x32_bf16 v[20:23], v[72:75], v[164:167], v[20:23]
    ds_read_b64_tr_b16 v[72:73], v7 offset:50176
    ds_read_b64_tr_b16 v[74:75], v7 offset:50688
    v_add_f32_dpp v244, v244, v244 quad_perm:[2,3,0,1] row_mask:0xf bank_mask:0xf
    s_add_u32 m0, s46, 65536
    v_mfma_f32_16x16x32_bf16 v[24:27], v[76:79], v[160:163], v[24:27]
    ds_read_b128 v[188:191], v6 offset:51200
    buffer_load_dwordx4 v4, s[12:15], s79 offen offset:0 lds
    v_mfma_f32_16x16x32_bf16 v[28:31], v[76:79], v[164:167], v[28:31]
    ds_read_b64_tr_b16 v[76:77], v8 offset:50176
    ds_read_b64_tr_b16 v[78:79], v8 offset:50688
    v_add_f32_dpp v244, v244, v244 row_half_mirror row_mask:0xf bank_mask:0xf
    s_waitcnt lgkmcnt(12)
    v_mfma_f32_16x16x32_bf16 v[48:51], v[80:83], v[168:171], v[48:51]
    v_add_f32_dpp v244, v244, v244 row_mirror row_mask:0xf bank_mask:0xf
    v_mov_b32 v252, v244
    v_mfma_f32_16x16x32_bf16 v[52:55], v[80:83], v[172:175], v[52:55]
    ds_read_b64_tr_b16 v[80:81], v7 offset:57344
    ds_read_b64_tr_b16 v[82:83], v7 offset:57856
    buffer_load_dwordx4 v4, s[16:19], s79 offen offset:1024 lds
    v_mfma_f32_16x16x32_bf16 v[56:59], v[84:87], v[168:171], v[56:59]
    v_mov_b32 v253, v244
    v_mfma_f32_16x16x32_bf16 v[60:63], v[84:87], v[172:175], v[60:63]
    ds_read_b64_tr_b16 v[84:85], v8 offset:57344
    ds_read_b64_tr_b16 v[86:87], v8 offset:57856
    v_permlane32_swap_b32 v252, v253
    v_add_f32 v244, v252, v253
    v_mfma_f32_16x16x32_bf16 v[16:19], v[88:91], v[168:171], v[16:19]
    v_mov_b32 v252, v244
    v_mov_b32 v253, v244
    v_mfma_f32_16x16x32_bf16 v[20:23], v[88:91], v[172:175], v[20:23]
    ds_read_b64_tr_b16 v[88:89], v7 offset:58368
    ds_read_b64_tr_b16 v[90:91], v7 offset:58880
    v_permlane16_swap_b32 v252, v253
    v_add_f32 v244, v252, v253
    v_mfma_f32_16x16x32_bf16 v[24:27], v[92:95], v[168:171], v[24:27]
    v_mul_f32 v244, s48, v244
    v_exp_f32 v244, -v244
    v_mfma_f32_16x16x32_bf16 v[28:31], v[92:95], v[172:175], v[28:31]
    ds_read_b64_tr_b16 v[92:93], v8 offset:58368
    ds_read_b64_tr_b16 v[94:95], v8 offset:58880
    v_add_f32 v244, 1.0, v244
    s_waitcnt vmcnt(8) lgkmcnt(8)
    s_barrier
    s_add_u32 m0, s46, 49152
    v_mfma_f32_16x16x32_bf16 v[48:51], v[64:67], v[176:179], v[48:51]
    ds_read_b128 v[192:195], v5 offset:0
    buffer_load_dwordx4 v2, s[8:11], s68 offen lds
    v_mfma_f32_16x16x32_bf16 v[52:55], v[64:67], v[180:183], v[52:55]
    ds_read_b64_tr_b16 v[64:65], v9 offset:0
    ds_read_b64_tr_b16 v[66:67], v9 offset:512
    v_mfma_f32_16x16x32_bf16 v[56:59], v[68:71], v[176:179], v[56:59]
    ds_read_b128 v[196:199], v5 offset:2048
    v_mfma_f32_16x16x32_bf16 v[60:63], v[68:71], v[180:183], v[60:63]
    ds_read_b64_tr_b16 v[68:69], v11 offset:0
    ds_read_b64_tr_b16 v[70:71], v11 offset:512
    buffer_load_dwordx4 v3, s[8:11], s68 offen offset:1024 lds
    v_mfma_f32_16x16x32_bf16 v[16:19], v[72:75], v[176:179], v[16:19]
    ds_read_b128 v[200:203], v6 offset:0
    v_mfma_f32_16x16x32_bf16 v[20:23], v[72:75], v[180:183], v[20:23]
    ds_read_b64_tr_b16 v[72:73], v9 offset:1024
    ds_read_b64_tr_b16 v[74:75], v9 offset:1536
    s_add_u32 m0, s46, 81920
    v_mfma_f32_16x16x32_bf16 v[24:27], v[76:79], v[176:179], v[24:27]
    ds_read_b128 v[204:207], v6 offset:2048
    buffer_load_dwordx4 v4, s[12:15], s69 offen offset:0 lds
    v_mfma_f32_16x16x32_bf16 v[28:31], v[76:79], v[180:183], v[28:31]
    ds_read_b64_tr_b16 v[76:77], v11 offset:1024
    ds_read_b64_tr_b16 v[78:79], v11 offset:1536
    s_waitcnt lgkmcnt(12)
    v_mfma_f32_16x16x32_bf16 v[48:51], v[80:83], v[184:187], v[48:51]
    v_mfma_f32_16x16x32_bf16 v[52:55], v[80:83], v[188:191], v[52:55]
    ds_read_b64_tr_b16 v[80:81], v9 offset:8192
    ds_read_b64_tr_b16 v[82:83], v9 offset:8704
    buffer_load_dwordx4 v4, s[16:19], s69 offen offset:1024 lds
    v_mfma_f32_16x16x32_bf16 v[56:59], v[84:87], v[184:187], v[56:59]
    v_mfma_f32_16x16x32_bf16 v[60:63], v[84:87], v[188:191], v[60:63]
    ds_read_b64_tr_b16 v[84:85], v11 offset:8192
    ds_read_b64_tr_b16 v[86:87], v11 offset:8704
    v_mfma_f32_16x16x32_bf16 v[16:19], v[88:91], v[184:187], v[16:19]
    v_mfma_f32_16x16x32_bf16 v[20:23], v[88:91], v[188:191], v[20:23]
    ds_read_b64_tr_b16 v[88:89], v9 offset:9216
    ds_read_b64_tr_b16 v[90:91], v9 offset:9728
    v_mfma_f32_16x16x32_bf16 v[24:27], v[92:95], v[184:187], v[24:27]
    v_mfma_f32_16x16x32_bf16 v[28:31], v[92:95], v[188:191], v[28:31]
    ds_read_b64_tr_b16 v[92:93], v11 offset:9216
    ds_read_b64_tr_b16 v[94:95], v11 offset:9728
    s_waitcnt vmcnt(8) lgkmcnt(8)
    s_barrier
    s_add_u32 m0, s46, 96256
    v_mfma_f32_16x16x32_bf16 v[48:51], v[64:67], v[192:195], v[48:51]
    ds_read_b128 v[208:211], v5 offset:16384
    buffer_load_dwordx4 v4, s[16:19], s37 offen offset:2048 lds
    v_mfma_f32_16x16x32_bf16 v[52:55], v[64:67], v[196:199], v[52:55]
    ds_read_b64_tr_b16 v[64:65], v9 offset:16384
    ds_read_b64_tr_b16 v[66:67], v9 offset:16896
    ds_write_b128 v110, v[240:243] offset:0
    ds_read_b64_tr_b16 v[98:99], v111 offset:0
    ds_read_b64_tr_b16 v[102:103], v111 offset:512
    v_mfma_f32_16x16x32_bf16 v[56:59], v[68:71], v[192:195], v[56:59]
    ds_read_b128 v[212:215], v5 offset:18432
    v_rcp_f32 v110, v244
    s_add_u32 m0, s46, 97280
    v_mfma_f32_16x16x32_bf16 v[60:63], v[68:71], v[196:199], v[60:63]
    ds_read_b64_tr_b16 v[68:69], v11 offset:16384
    ds_read_b64_tr_b16 v[70:71], v11 offset:16896
    buffer_load_dwordx4 v4, s[16:19], s65 offen offset:2048 lds
    v_mfma_f32_16x16x32_bf16 v[16:19], v[72:75], v[192:195], v[16:19]
    ds_read_b128 v[216:219], v6 offset:16384
    s_lshl_b32 s92, s31, 2
    v_mov_b32 v252, s92
    v_mfma_f32_16x16x32_bf16 v[20:23], v[72:75], v[196:199], v[20:23]
    ds_read_b64_tr_b16 v[72:73], v9 offset:17408
    ds_read_b64_tr_b16 v[74:75], v9 offset:17920
    ds_write_b32 v252, v110 offset:8192
    v_mfma_f32_16x16x32_bf16 v[24:27], v[76:79], v[192:195], v[24:27]
    ds_read_b128 v[220:223], v6 offset:18432
    v_mfma_f32_16x16x32_bf16 v[28:31], v[76:79], v[196:199], v[28:31]
    ds_read_b64_tr_b16 v[76:77], v11 offset:17408
    ds_read_b64_tr_b16 v[78:79], v11 offset:17920
    s_waitcnt lgkmcnt(15)
    v_mfma_f32_16x16x32_bf16 v[48:51], v[80:83], v[200:203], v[48:51]
    v_mfma_f32_16x16x32_bf16 v[52:55], v[80:83], v[204:207], v[52:55]
    ds_read_b64_tr_b16 v[80:81], v9 offset:24576
    ds_read_b64_tr_b16 v[82:83], v9 offset:25088
    v_mfma_f32_16x16x32_bf16 v[56:59], v[84:87], v[200:203], v[56:59]
    v_mfma_f32_16x16x32_bf16 v[60:63], v[84:87], v[204:207], v[60:63]
    ds_read_b64_tr_b16 v[84:85], v11 offset:24576
    ds_read_b64_tr_b16 v[86:87], v11 offset:25088
    v_mfma_f32_16x16x32_bf16 v[16:19], v[88:91], v[200:203], v[16:19]
    v_mfma_f32_16x16x32_bf16 v[20:23], v[88:91], v[204:207], v[20:23]
    ds_read_b64_tr_b16 v[88:89], v9 offset:25600
    ds_read_b64_tr_b16 v[90:91], v9 offset:26112
    v_mfma_f32_16x16x32_bf16 v[24:27], v[92:95], v[200:203], v[24:27]
    v_mfma_f32_16x16x32_bf16 v[28:31], v[92:95], v[204:207], v[28:31]
    ds_read_b64_tr_b16 v[92:93], v11 offset:25600
    ds_read_b64_tr_b16 v[94:95], v11 offset:26112
    s_waitcnt vmcnt(6) lgkmcnt(8)
    s_barrier
    s_add_u32 m0, s46, 112640
    v_mfma_f32_16x16x32_bf16 v[48:51], v[64:67], v[208:211], v[48:51]
    ds_read_b128 v[224:227], v5 offset:32768
    buffer_load_dwordx4 v4, s[16:19], s67 offen offset:2048 lds
    v_mfma_f32_16x16x32_bf16 v[52:55], v[64:67], v[212:215], v[52:55]
    ds_read_b64_tr_b16 v[64:65], v7 offset:0
    ds_read_b64_tr_b16 v[66:67], v7 offset:512
    s_waitcnt lgkmcnt(15)
    v_lshlrev_b32 v13, 16, v98
    v_and_b32 v15, 0xffff0000, v98
    v_mfma_f32_16x16x32_bf16 v[56:59], v[68:71], v[208:211], v[56:59]
    ds_read_b128 v[228:231], v5 offset:34816
    v_mul_f32 v13, s48, v13
    v_mul_f32 v15, s48, v15
    s_add_u32 m0, s46, 113664
    v_mfma_f32_16x16x32_bf16 v[60:63], v[68:71], v[212:215], v[60:63]
    ds_read_b64_tr_b16 v[68:69], v8 offset:0
    ds_read_b64_tr_b16 v[70:71], v8 offset:512
    buffer_load_dwordx4 v4, s[16:19], s71 offen offset:2048 lds
    v_mfma_f32_16x16x32_bf16 v[16:19], v[72:75], v[208:211], v[16:19]
    ds_read_b128 v[232:235], v6 offset:32768
    v_cvt_pk_bf16_f32 v98, v13, v15
    v_lshlrev_b32 v13, 16, v99
    v_mfma_f32_16x16x32_bf16 v[20:23], v[72:75], v[212:215], v[20:23]
    ds_read_b64_tr_b16 v[72:73], v7 offset:1024
    ds_read_b64_tr_b16 v[74:75], v7 offset:1536
    v_and_b32 v15, 0xffff0000, v99
    v_mul_f32 v13, s48, v13
    v_mfma_f32_16x16x32_bf16 v[24:27], v[76:79], v[208:211], v[24:27]
    ds_read_b128 v[236:239], v6 offset:34816
    v_mul_f32 v15, s48, v15
    v_cvt_pk_bf16_f32 v99, v13, v15
    v_mfma_f32_16x16x32_bf16 v[28:31], v[76:79], v[212:215], v[28:31]
    ds_read_b64_tr_b16 v[76:77], v8 offset:1024
    ds_read_b64_tr_b16 v[78:79], v8 offset:1536
    v_lshlrev_b32 v13, 16, v102
    v_and_b32 v15, 0xffff0000, v102
    s_waitcnt lgkmcnt(12)
    v_mfma_f32_16x16x32_bf16 v[48:51], v[80:83], v[216:219], v[48:51]
    v_mul_f32 v13, s48, v13
    v_mul_f32 v15, s48, v15
    v_mfma_f32_16x16x32_bf16 v[52:55], v[80:83], v[220:223], v[52:55]
    ds_read_b64_tr_b16 v[80:81], v7 offset:8192
    ds_read_b64_tr_b16 v[82:83], v7 offset:8704
    v_cvt_pk_bf16_f32 v102, v13, v15
    v_lshlrev_b32 v13, 16, v103
    v_mfma_f32_16x16x32_bf16 v[56:59], v[84:87], v[216:219], v[56:59]
    v_and_b32 v15, 0xffff0000, v103
    v_mul_f32 v13, s48, v13
    v_mfma_f32_16x16x32_bf16 v[60:63], v[84:87], v[220:223], v[60:63]
    ds_read_b64_tr_b16 v[84:85], v8 offset:8192
    ds_read_b64_tr_b16 v[86:87], v8 offset:8704
    v_mul_f32 v15, s48, v15
    v_cvt_pk_bf16_f32 v103, v13, v15
    v_mfma_f32_16x16x32_bf16 v[16:19], v[88:91], v[216:219], v[16:19]
    v_mfma_f32_16x16x32_bf16 v[20:23], v[88:91], v[220:223], v[20:23]
    ds_read_b64_tr_b16 v[88:89], v7 offset:9216
    ds_read_b64_tr_b16 v[90:91], v7 offset:9728
    v_mfma_f32_16x16x32_bf16 v[24:27], v[92:95], v[216:219], v[24:27]
    v_mfma_f32_16x16x32_bf16 v[28:31], v[92:95], v[220:223], v[28:31]
    ds_read_b64_tr_b16 v[92:93], v8 offset:9216
    ds_read_b64_tr_b16 v[94:95], v8 offset:9728
    s_waitcnt vmcnt(4) lgkmcnt(8)
    s_barrier
    s_add_u32 m0, s46, 129024
    v_mfma_f32_16x16x32_bf16 v[48:51], v[64:67], v[224:227], v[48:51]
    ds_read_b128 v[240:243], v5 offset:49152
    buffer_load_dwordx4 v4, s[16:19], s73 offen offset:2048 lds
    v_mfma_f32_16x16x32_bf16 v[52:55], v[64:67], v[228:231], v[52:55]
    ds_read_b64_tr_b16 v[64:65], v7 offset:16384
    ds_read_b64_tr_b16 v[66:67], v7 offset:16896
    v_mfma_f32_16x16x32_bf16 v[56:59], v[68:71], v[224:227], v[56:59]
    ds_read_b128 v[244:247], v5 offset:51200
    s_add_u32 m0, s46, 130048
    v_mfma_f32_16x16x32_bf16 v[60:63], v[68:71], v[228:231], v[60:63]
    ds_read_b64_tr_b16 v[68:69], v8 offset:16384
    ds_read_b64_tr_b16 v[70:71], v8 offset:16896
    buffer_load_dwordx4 v4, s[16:19], s75 offen offset:2048 lds
    v_mfma_f32_16x16x32_bf16 v[16:19], v[72:75], v[224:227], v[16:19]
    ds_read_b128 v[248:251], v6 offset:49152
    v_mfma_f32_16x16x32_bf16 v[20:23], v[72:75], v[228:231], v[20:23]
    ds_read_b64_tr_b16 v[72:73], v7 offset:17408
    ds_read_b64_tr_b16 v[74:75], v7 offset:17920
    v_mfma_f32_16x16x32_bf16 v[24:27], v[76:79], v[224:227], v[24:27]
    ds_read_b128 v[252:255], v6 offset:51200
    v_mfma_f32_16x16x32_bf16 v[28:31], v[76:79], v[228:231], v[28:31]
    ds_read_b64_tr_b16 v[76:77], v8 offset:17408
    ds_read_b64_tr_b16 v[78:79], v8 offset:17920
    s_waitcnt lgkmcnt(12)
    v_mfma_f32_16x16x32_bf16 v[48:51], v[80:83], v[232:235], v[48:51]
    v_mfma_f32_16x16x32_bf16 v[52:55], v[80:83], v[236:239], v[52:55]
    ds_read_b64_tr_b16 v[80:81], v7 offset:24576
    ds_read_b64_tr_b16 v[82:83], v7 offset:25088
    v_mfma_f32_16x16x32_bf16 v[56:59], v[84:87], v[232:235], v[56:59]
    v_mfma_f32_16x16x32_bf16 v[60:63], v[84:87], v[236:239], v[60:63]
    ds_read_b64_tr_b16 v[84:85], v8 offset:24576
    ds_read_b64_tr_b16 v[86:87], v8 offset:25088
    v_mfma_f32_16x16x32_bf16 v[16:19], v[88:91], v[232:235], v[16:19]
    v_mfma_f32_16x16x32_bf16 v[20:23], v[88:91], v[236:239], v[20:23]
    ds_read_b64_tr_b16 v[88:89], v7 offset:25600
    ds_read_b64_tr_b16 v[90:91], v7 offset:26112
    v_mfma_f32_16x16x32_bf16 v[24:27], v[92:95], v[232:235], v[24:27]
    v_mfma_f32_16x16x32_bf16 v[28:31], v[92:95], v[236:239], v[28:31]
    ds_read_b64_tr_b16 v[92:93], v8 offset:25600
    ds_read_b64_tr_b16 v[94:95], v8 offset:26112
    s_waitcnt vmcnt(2) lgkmcnt(8)
    s_barrier
    s_add_u32 m0, s46, 145408
    v_mfma_f32_16x16x32_bf16 v[48:51], v[64:67], v[240:243], v[48:51]
    buffer_load_dwordx4 v4, s[16:19], s79 offen offset:2048 lds
    v_mfma_f32_16x16x32_bf16 v[52:55], v[64:67], v[244:247], v[52:55]
    ds_read_b64_tr_b16 v[64:65], v7 offset:32768
    ds_read_b64_tr_b16 v[66:67], v7 offset:33280
    ds_read_b32 v110, v121 offset:8192
    v_mfma_f32_16x16x32_bf16 v[56:59], v[68:71], v[240:243], v[56:59]
    s_add_u32 m0, s46, 146432
    v_mfma_f32_16x16x32_bf16 v[60:63], v[68:71], v[244:247], v[60:63]
    ds_read_b64_tr_b16 v[68:69], v8 offset:32768
    ds_read_b64_tr_b16 v[70:71], v8 offset:33280
    buffer_load_dwordx4 v4, s[16:19], s69 offen offset:2048 lds
    v_mfma_f32_16x16x32_bf16 v[16:19], v[72:75], v[240:243], v[16:19]
    v_mfma_f32_16x16x32_bf16 v[20:23], v[72:75], v[244:247], v[20:23]
    ds_read_b64_tr_b16 v[72:73], v7 offset:40960
    ds_read_b64_tr_b16 v[74:75], v7 offset:41472
    v_mfma_f32_16x16x32_bf16 v[24:27], v[76:79], v[240:243], v[24:27]
    buffer_load_dword v111, v121, s[4:7], 0 offen sc1
    v_mfma_f32_16x16x32_bf16 v[28:31], v[76:79], v[244:247], v[28:31]
    ds_read_b64_tr_b16 v[76:77], v8 offset:40960
    ds_read_b64_tr_b16 v[78:79], v8 offset:41472
    s_waitcnt lgkmcnt(9)
    v_mfma_f32_16x16x32_bf16 v[48:51], v[80:83], v[248:251], v[48:51]
    v_mfma_f32_16x16x32_bf16 v[52:55], v[80:83], v[252:255], v[52:55]
    ds_read_b64_tr_b16 v[80:81], v7 offset:33792
    ds_read_b64_tr_b16 v[82:83], v7 offset:34304
    v_mfma_f32_16x16x32_bf16 v[56:59], v[84:87], v[248:251], v[56:59]
    v_mfma_f32_16x16x32_bf16 v[60:63], v[84:87], v[252:255], v[60:63]
    ds_read_b64_tr_b16 v[84:85], v8 offset:33792
    ds_read_b64_tr_b16 v[86:87], v8 offset:34304
    v_mfma_f32_16x16x32_bf16 v[16:19], v[88:91], v[248:251], v[16:19]
    v_mfma_f32_16x16x32_bf16 v[20:23], v[88:91], v[252:255], v[20:23]
    ds_read_b64_tr_b16 v[88:89], v7 offset:41984
    ds_read_b64_tr_b16 v[90:91], v7 offset:42496
    v_mfma_f32_16x16x32_bf16 v[24:27], v[92:95], v[248:251], v[24:27]
    v_mfma_f32_16x16x32_bf16 v[28:31], v[92:95], v[252:255], v[28:31]
    ds_read_b64_tr_b16 v[92:93], v8 offset:41984
    ds_read_b64_tr_b16 v[94:95], v8 offset:42496
    s_waitcnt lgkmcnt(8)
    v_mfma_f32_16x16x32_bf16 v[32:35], v[128:131], v[64:67], 0
    v_mul_f32 v48, s49, v48
    v_mul_f32 v49, s49, v49
    v_mul_f32 v50, s49, v50
    v_mul_f32 v51, s49, v51
    v_mfma_f32_16x16x32_bf16 v[36:39], v[132:135], v[64:67], 0
    ds_read_b64_tr_b16 v[64:65], v7 offset:49152
    ds_read_b64_tr_b16 v[66:67], v7 offset:49664
    v_mul_f32 v52, s49, v52
    v_mul_f32 v53, s49, v53
    v_mul_f32 v54, s49, v54
    v_mul_f32 v55, s49, v55
    v_mfma_f32_16x16x32_bf16 v[40:43], v[128:131], v[68:71], 0
    v_cvt_pk_bf16_f32 v48, v48, v49
    v_cvt_pk_bf16_f32 v49, v50, v51
    v_cvt_pk_bf16_f32 v50, v52, v53
    v_cvt_pk_bf16_f32 v51, v54, v55
    v_mfma_f32_16x16x32_bf16 v[44:47], v[132:135], v[68:71], 0
    ds_read_b64_tr_b16 v[68:69], v8 offset:49152
    ds_read_b64_tr_b16 v[70:71], v8 offset:49664
    v_mul_f32 v56, s49, v56
    v_mul_f32 v57, s49, v57
    v_permlane16_swap_b32 v48, v50
    v_permlane16_swap_b32 v49, v51
    v_mfma_f32_16x16x32_bf16 v[32:35], v[136:139], v[72:75], v[32:35]
    v_mul_f32 v58, s49, v58
    v_mul_f32 v59, s49, v59
    s_add_u32 s54, s53, 0
    buffer_store_dwordx4 v[48:51], v0, s[20:23], s54 offen sc1
    v_mfma_f32_16x16x32_bf16 v[36:39], v[140:143], v[72:75], v[36:39]
    ds_read_b64_tr_b16 v[72:73], v7 offset:57344
    ds_read_b64_tr_b16 v[74:75], v7 offset:57856
    v_mul_f32 v60, s49, v60
    v_mul_f32 v61, s49, v61
    v_mul_f32 v62, s49, v62
    v_mul_f32 v63, s49, v63
    v_mfma_f32_16x16x32_bf16 v[40:43], v[136:139], v[76:79], v[40:43]
    v_cvt_pk_bf16_f32 v56, v56, v57
    v_cvt_pk_bf16_f32 v57, v58, v59
    v_cvt_pk_bf16_f32 v58, v60, v61
    v_cvt_pk_bf16_f32 v59, v62, v63
    v_mfma_f32_16x16x32_bf16 v[44:47], v[140:143], v[76:79], v[44:47]
    ds_read_b64_tr_b16 v[76:77], v8 offset:57344
    ds_read_b64_tr_b16 v[78:79], v8 offset:57856
    v_cvt_pk_bf16_f32 v16, v16, v17
    v_cvt_pk_bf16_f32 v17, v18, v19
    v_permlane16_swap_b32 v56, v58
    v_permlane16_swap_b32 v57, v59
    s_waitcnt lgkmcnt(8)
    v_mfma_f32_16x16x32_bf16 v[32:35], v[144:147], v[80:83], v[32:35]
    v_cvt_pk_bf16_f32 v18, v20, v21
    v_cvt_pk_bf16_f32 v19, v22, v23
    s_add_u32 s54, s53, 65536
    buffer_store_dwordx4 v[56:59], v0, s[20:23], s54 offen sc1
    v_mfma_f32_16x16x32_bf16 v[36:39], v[148:151], v[80:83], v[36:39]
    ds_read_b64_tr_b16 v[80:81], v7 offset:50176
    ds_read_b64_tr_b16 v[82:83], v7 offset:50688
    v_cvt_pk_bf16_f32 v24, v24, v25
    v_cvt_pk_bf16_f32 v25, v26, v27
    v_mfma_f32_16x16x32_bf16 v[48:51], v[98:101], v[16:19], 0
    v_mfma_f32_16x16x32_bf16 v[52:55], v[96:99], v[16:19], 0
    v_mfma_f32_16x16x32_bf16 v[40:43], v[144:147], v[84:87], v[40:43]
    v_cvt_pk_bf16_f32 v26, v28, v29
    v_cvt_pk_bf16_f32 v27, v30, v31
    ds_write2_b32 v12, v122, v122 offset1:1
    ds_write2_b32 v12, v122, v122 offset0:2 offset1:3
    v_mfma_f32_16x16x32_bf16 v[44:47], v[148:151], v[84:87], v[44:47]
    ds_read_b64_tr_b16 v[84:85], v8 offset:50176
    ds_read_b64_tr_b16 v[86:87], v8 offset:50688
    ds_write_b32 v121, v96 offset:63488
    v_mfma_f32_16x16x32_bf16 v[56:59], v[102:105], v[24:27], 0
    v_mfma_f32_16x16x32_bf16 v[60:63], v[100:103], v[24:27], 0
    v_and_b32 v13, 1, v1
    v_mfma_f32_16x16x32_bf16 v[32:35], v[152:155], v[88:91], v[32:35]
    v_lshrrev_b32 v15, 5, v1
    v_cmp_eq_u32 s[58:59], v13, v15
    v_mov_b32 v13, 0x3f803f80
    s_nop 0
    v_mfma_f32_16x16x32_bf16 v[36:39], v[156:159], v[88:91], v[36:39]
    ds_read_b64_tr_b16 v[88:89], v7 offset:58368
    ds_read_b64_tr_b16 v[90:91], v7 offset:58880
    v_cndmask_b32 v20, 0, v13, s[58:59]
    v_cndmask_b32 v21, 0, v13, s[58:59]
    v_cndmask_b32 v22, 0, v13, s[58:59]
    v_cndmask_b32 v23, 0, v13, s[58:59]
    v_mfma_f32_16x16x32_bf16 v[40:43], v[152:155], v[92:95], v[40:43]
    v_mov_b32 v28, 0x3f803f80
    v_mov_b32 v29, 0x3f803f80
    v_mov_b32 v30, 0x3f803f80
    v_mov_b32 v31, 0x3f803f80
    v_mfma_f32_16x16x32_bf16 v[44:47], v[156:159], v[92:95], v[44:47]
    ds_read_b64_tr_b16 v[92:93], v8 offset:58368
    ds_read_b64_tr_b16 v[94:95], v8 offset:58880
    s_waitcnt vmcnt(3) lgkmcnt(11)
    s_barrier
    v_mfma_f32_16x16x32_bf16 v[32:35], v[160:163], v[64:67], v[32:35]
    v_exp_f32 v128, v48
    v_exp_f32 v132, -v48
    v_mfma_f32_16x16x32_bf16 v[36:39], v[164:167], v[64:67], v[36:39]
    ds_read_b64_tr_b16 v[64:65], v9 offset:0
    ds_read_b64_tr_b16 v[66:67], v9 offset:512
    v_exp_f32 v129, v49
    v_exp_f32 v133, -v49
    v_mfma_f32_16x16x32_bf16 v[40:43], v[160:163], v[68:71], v[40:43]
    v_exp_f32 v130, v50
    v_exp_f32 v134, -v50
    v_mfma_f32_16x16x32_bf16 v[44:47], v[164:167], v[68:71], v[44:47]
    ds_read_b64_tr_b16 v[68:69], v11 offset:0
    ds_read_b64_tr_b16 v[70:71], v11 offset:512
    v_exp_f32 v131, v51
    v_exp_f32 v135, -v51
    v_mfma_f32_16x16x32_bf16 v[32:35], v[168:171], v[72:75], v[32:35]
    v_exp_f32 v136, v52
    v_exp_f32 v140, -v52
    v_mfma_f32_16x16x32_bf16 v[36:39], v[172:175], v[72:75], v[36:39]
    ds_read_b64_tr_b16 v[72:73], v9 offset:8192
    ds_read_b64_tr_b16 v[74:75], v9 offset:8704
    v_exp_f32 v137, v53
    v_exp_f32 v141, -v53
    v_mfma_f32_16x16x32_bf16 v[40:43], v[168:171], v[76:79], v[40:43]
    v_exp_f32 v138, v54
    v_exp_f32 v142, -v54
    v_mfma_f32_16x16x32_bf16 v[44:47], v[172:175], v[76:79], v[44:47]
    ds_read_b64_tr_b16 v[76:77], v11 offset:8192
    ds_read_b64_tr_b16 v[78:79], v11 offset:8704
    v_exp_f32 v139, v55
    v_exp_f32 v143, -v55
    s_waitcnt lgkmcnt(8)
    s_waitcnt vmcnt(0)
    v_cmp_eq_u32 vcc, 0, v111
    s_cmp_lg_u64 vcc, 0
    s_cbranch_scc1 L_fs26
L_fb27:
    s_barrier
    s_cmp_lg_u32 s31, 0
    s_cbranch_scc1 L_w0_30
    s_mov_b64 exec, 1
    buffer_store_dword v111, v96, s[20:23], s77 offen sc1
    s_mov_b64 exec, -1
L_w0_30:
    v_mfma_f32_16x16x32_bf16 v[32:35], v[176:179], v[80:83], v[32:35]
    v_exp_f32 v144, v56
    v_exp_f32 v148, -v56
    v_mfma_f32_16x16x32_bf16 v[36:39], v[180:183], v[80:83], v[36:39]
    ds_read_b64_tr_b16 v[80:81], v9 offset:1024
    ds_read_b64_tr_b16 v[82:83], v9 offset:1536
    v_exp_f32 v145, v57
    v_exp_f32 v149, -v57
    v_mfma_f32_16x16x32_bf16 v[40:43], v[176:179], v[84:87], v[40:43]
    v_exp_f32 v146, v58
    v_exp_f32 v150, -v58
    v_mfma_f32_16x16x32_bf16 v[44:47], v[180:183], v[84:87], v[44:47]
    ds_read_b64_tr_b16 v[84:85], v11 offset:1024
    ds_read_b64_tr_b16 v[86:87], v11 offset:1536
    v_exp_f32 v147, v59
    v_exp_f32 v151, -v59
    v_mfma_f32_16x16x32_bf16 v[32:35], v[184:187], v[88:91], v[32:35]
    v_exp_f32 v152, v60
    v_exp_f32 v156, -v60
    v_mfma_f32_16x16x32_bf16 v[36:39], v[188:191], v[88:91], v[36:39]
    ds_read_b64_tr_b16 v[88:89], v9 offset:9216
    ds_read_b64_tr_b16 v[90:91], v9 offset:9728
    v_exp_f32 v153, v61
    v_exp_f32 v157, -v61
    v_mfma_f32_16x16x32_bf16 v[40:43], v[184:187], v[92:95], v[40:43]
    v_exp_f32 v154, v62
    v_exp_f32 v158, -v62
    v_mfma_f32_16x16x32_bf16 v[44:47], v[188:191], v[92:95], v[44:47]
    ds_read_b64_tr_b16 v[92:93], v11 offset:9216
    ds_read_b64_tr_b16 v[94:95], v11 offset:9728
    v_exp_f32 v155, v63
    v_exp_f32 v159, -v63
    s_waitcnt lgkmcnt(8)
    v_mfma_f32_16x16x32_bf16 v[32:35], v[192:195], v[64:67], v[32:35]
    v_max3_f32 v13, abs(v48), abs(v49), abs(v50)
    v_max3_f32 v15, abs(v51), abs(v52), abs(v53)
    v_max3_f32 v13, v13, abs(v54), abs(v55)
    v_max3_f32 v15, v15, abs(v56), abs(v57)
    v_mfma_f32_16x16x32_bf16 v[36:39], v[196:199], v[64:67], v[36:39]
    ds_read_b64_tr_b16 v[64:65], v9 offset:16384
    ds_read_b64_tr_b16 v[66:67], v9 offset:16896
    v_max3_f32 v13, v13, abs(v58), abs(v59)
    v_max3_f32 v15, v15, abs(v60), abs(v61)
    v_max3_f32 v13, v13, abs(v62), abs(v63)
    v_mov_b32 v160, 0
    v_mfma_f32_16x16x32_bf16 v[40:43], v[192:195], v[68:71], v[40:43]
    v_mov_b32 v161, 0
    v_mov_b32 v164, 0
    v_mov_b32 v165, 0
    v_mov_b32 v168, 0
    v_mfma_f32_16x16x32_bf16 v[44:47], v[196:199], v[68:71], v[44:47]
    ds_read_b64_tr_b16 v[68:69], v11 offset:16384
    ds_read_b64_tr_b16 v[70:71], v11 offset:16896
    v_mov_b32 v169, 0
    v_mov_b32 v172, 0
    v_mov_b32 v173, 0
    v_max_f32 v13, v13, v15
    v_cmp_nlt_f32 vcc, v13, s50
    s_cmp_lg_u64 vcc, 0
    s_cbranch_scc1 L_phs24
L_phj25:
    v_mfma_f32_16x16x32_bf16 v[32:35], v[200:203], v[72:75], v[32:35]
    v_smfmac_f32_16x16x64_bf16 v[160:163], v[20:23], v[128:135], v10
    v_mfma_f32_16x16x32_bf16 v[36:39], v[204:207], v[72:75], v[36:39]
    ds_read_b64_tr_b16 v[72:73], v9 offset:24576
    ds_read_b64_tr_b16 v[74:75], v9 offset:25088
    v_smfmac_f32_16x16x64_bf16 v[164:167], v[20:23], v[136:143], v10
    v_smfmac_f32_16x16x64_bf16 v[168:171], v[20:23], v[144:151], v10
    v_smfmac_f32_16x16x64_bf16 v[172:175], v[20:23], v[152:159], v10
    v_mfma_f32_16x16x32_bf16 v[40:43], v[200:203], v[76:79], v[40:43]
    v_mfma_f32_16x16x32_bf16 v[44:47], v[204:207], v[76:79], v[44:47]
    ds_read_b64_tr_b16 v[76:77], v11 offset:24576
    ds_read_b64_tr_b16 v[78:79], v11 offset:25088
    v_rcp_f32 v160, v160
    v_rcp_f32 v161, v161
    s_waitcnt lgkmcnt(8)
    s_cmp_lg_u32 s31, 1
    s_cbranch_scc1 L_gs23
    s_waitcnt lgkmcnt(15)
    s_mov_b32 exec_hi, 0
    buffer_store_dword v110, v121, s[20:23], s96 offen sc1
    s_mov_b32 exec_hi, -1
L_gs23:
    v_mfma_f32_16x16x32_bf16 v[32:35], v[208:211], v[80:83], v[32:35]
    v_rcp_f32 v164, v164
    v_rcp_f32 v165, v165
    v_mfma_f32_16x16x32_bf16 v[36:39], v[212:215], v[80:83], v[36:39]
    ds_read_b64_tr_b16 v[80:81], v9 offset:17408
    ds_read_b64_tr_b16 v[82:83], v9 offset:17920
    v_rcp_f32 v168, v168
    v_rcp_f32 v169, v169
    v_mfma_f32_16x16x32_bf16 v[40:43], v[208:211], v[84:87], v[40:43]
    v_rcp_f32 v172, v172
    v_rcp_f32 v173, v173
    v_mfma_f32_16x16x32_bf16 v[44:47], v[212:215], v[84:87], v[44:47]
    ds_read_b64_tr_b16 v[84:85], v11 offset:17408
    ds_read_b64_tr_b16 v[86:87], v11 offset:17920
    v_mul_f32 v128, v128, v160
    v_mul_f32 v129, v129, v160
    v_mul_f32 v130, v130, v160
    v_mul_f32 v131, v131, v160
    s_mov_b64 exec, 0x3f
    buffer_load_dword v4, v127, s[20:23], 0 offen sc1
    s_mov_b64 exec, -1
    v_mfma_f32_16x16x32_bf16 v[32:35], v[216:219], v[88:91], v[32:35]
    v_mul_f32 v132, v132, v161
    v_mul_f32 v133, v133, v161
    v_mul_f32 v134, v134, v161
    v_mul_f32 v135, v135, v161
    v_mfma_f32_16x16x32_bf16 v[36:39], v[220:223], v[88:91], v[36:39]
    ds_read_b64_tr_b16 v[88:89], v9 offset:25600
    ds_read_b64_tr_b16 v[90:91], v9 offset:26112
    v_cvt_pk_bf16_f32 v128, v128, v129
    v_cvt_pk_bf16_f32 v129, v130, v131
    v_cvt_pk_bf16_f32 v130, v132, v133
    v_cvt_pk_bf16_f32 v131, v134, v135
    v_mfma_f32_16x16x32_bf16 v[40:43], v[216:219], v[92:95], v[40:43]
    v_mul_f32 v136, v136, v164
    v_mul_f32 v137, v137, v164
    v_mfma_f32_16x16x32_bf16 v[176:179], v[128:131], v[106:109], 0
    v_mfma_f32_16x16x32_bf16 v[184:187], v[128:131], v[104:107], 0
    v_mfma_f32_16x16x32_bf16 v[44:47], v[220:223], v[92:95], v[44:47]
    ds_read_b64_tr_b16 v[92:93], v11 offset:25600
    ds_read_b64_tr_b16 v[94:95], v11 offset:26112
    v_mul_f32 v138, v138, v164
    v_mul_f32 v139, v139, v164
    v_mul_f32 v140, v140, v165
    v_mul_f32 v141, v141, v165
    s_waitcnt lgkmcnt(8)
    v_mfma_f32_16x16x32_bf16 v[32:35], v[224:227], v[64:67], v[32:35]
    v_mul_f32 v142, v142, v165
    v_mul_f32 v143, v143, v165
    v_cvt_pk_bf16_f32 v136, v136, v137
    v_cvt_pk_bf16_f32 v137, v138, v139
    v_mfma_f32_16x16x32_bf16 v[36:39], v[228:231], v[64:67], v[36:39]
    v_cvt_pk_bf16_f32 v138, v140, v141
    v_cvt_pk_bf16_f32 v139, v142, v143
    v_mul_f32 v144, v144, v168
    v_mul_f32 v145, v145, v168
    v_mfma_f32_16x16x32_bf16 v[40:43], v[224:227], v[68:71], v[40:43]
    v_mfma_f32_16x16x32_bf16 v[180:183], v[136:139], v[106:109], 0
    v_mfma_f32_16x16x32_bf16 v[188:191], v[136:139], v[104:107], 0
    v_mul_f32 v146, v146, v168
    v_mul_f32 v147, v147, v168
    v_mfma_f32_16x16x32_bf16 v[44:47], v[228:231], v[68:71], v[44:47]
    v_mul_f32 v148, v148, v169
    v_mul_f32 v149, v149, v169
    v_mul_f32 v150, v150, v169
    v_mul_f32 v151, v151, v169
    v_mfma_f32_16x16x32_bf16 v[32:35], v[232:235], v[72:75], v[32:35]
    v_cvt_pk_bf16_f32 v144, v144, v145
    v_cvt_pk_bf16_f32 v145, v146, v147
    v_cvt_pk_bf16_f32 v146, v148, v149
    v_cvt_pk_bf16_f32 v147, v150, v151
    v_mfma_f32_16x16x32_bf16 v[36:39], v[236:239], v[72:75], v[36:39]
    v_mul_f32 v152, v152, v172
    v_mul_f32 v153, v153, v172
    v_mfma_f32_16x16x32_bf16 v[192:195], v[144:147], v[106:109], 0
    v_mfma_f32_16x16x32_bf16 v[200:203], v[144:147], v[104:107], 0
    v_mfma_f32_16x16x32_bf16 v[40:43], v[232:235], v[76:79], v[40:43]
    v_mul_f32 v154, v154, v172
    v_mul_f32 v155, v155, v172
    v_mul_f32 v156, v156, v173
    v_mul_f32 v157, v157, v173
    v_mfma_f32_16x16x32_bf16 v[44:47], v[236:239], v[76:79], v[44:47]
    v_mul_f32 v158, v158, v173
    v_mul_f32 v159, v159, v173
    v_cvt_pk_bf16_f32 v152, v152, v153
    v_cvt_pk_bf16_f32 v153, v154, v155
    s_waitcnt lgkmcnt(0)
    v_mfma_f32_16x16x32_bf16 v[32:35], v[240:243], v[80:83], v[32:35]
    v_cvt_pk_bf16_f32 v154, v156, v157
    v_cvt_pk_bf16_f32 v155, v158, v159
    v_cvt_pk_bf16_f32 v132, v176, v177
    v_cvt_pk_bf16_f32 v133, v178, v179
    v_mfma_f32_16x16x32_bf16 v[36:39], v[244:247], v[80:83], v[36:39]
    v_mfma_f32_16x16x32_bf16 v[196:199], v[152:155], v[106:109], 0
    v_mfma_f32_16x16x32_bf16 v[204:207], v[152:155], v[104:107], 0
    v_cvt_pk_bf16_f32 v134, v180, v181
    v_cvt_pk_bf16_f32 v135, v182, v183
    s_waitcnt vmcnt(0)
    v_cmp_gt_u32 vcc, 1, v4
    s_and_b32 s56, vcc_lo, 0x3f
    s_cbranch_scc1 L_qs31
L_qb32:
    buffer_load_dwordx4 v[208:211], v0, s[20:23], s63 offen sc1
    s_add_u32 s95, s63, 4096
    buffer_load_dwordx4 v[212:215], v0, s[20:23], s95 offen sc1
    v_mfma_f32_16x16x32_bf16 v[40:43], v[240:243], v[84:87], v[40:43]
    v_cvt_pk_bf16_f32 v140, v184, v185
    v_cvt_pk_bf16_f32 v141, v186, v187
    v_mfma_f32_16x16x32_bf16 v[180:183], v[132:135], v[28:31], 0
    v_cvt_pk_bf16_f32 v142, v188, v189
    v_mfma_f32_16x16x32_bf16 v[44:47], v[244:247], v[84:87], v[44:47]
    v_cvt_pk_bf16_f32 v143, v190, v191
    v_cvt_pk_bf16_f32 v148, v192, v193
    v_cvt_pk_bf16_f32 v149, v194, v195
    v_mfma_f32_16x16x32_bf16 v[188:191], v[140:143], v[28:31], 0
    buffer_load_dwordx4 v[2:5], v0, s[20:23], s34 offen sc1
    buffer_load_dwordx4 v[6:9], v0, s[20:23], s29 offen sc1
    v_mfma_f32_16x16x32_bf16 v[32:35], v[248:251], v[88:91], v[32:35]
    v_cvt_pk_bf16_f32 v150, v196, v197
    v_cvt_pk_bf16_f32 v151, v198, v199
    v_cvt_pk_bf16_f32 v156, v200, v201
    v_cvt_pk_bf16_f32 v157, v202, v203
    v_mfma_f32_16x16x32_bf16 v[36:39], v[252:255], v[88:91], v[36:39]
    v_mfma_f32_16x16x32_bf16 v[196:199], v[148:151], v[28:31], 0
    v_cvt_pk_bf16_f32 v158, v204, v205
    v_cvt_pk_bf16_f32 v159, v206, v207
    s_nop 0
    s_add_u32 s95, s63, 8192
    buffer_load_dwordx4 v[216:219], v0, s[20:23], s95 offen sc1
    s_add_u32 s95, s63, 12288
    buffer_load_dwordx4 v[220:223], v0, s[20:23], s95 offen sc1
    v_mfma_f32_16x16x32_bf16 v[40:43], v[248:251], v[92:95], v[40:43]
    v_mfma_f32_16x16x32_bf16 v[204:207], v[156:159], v[28:31], 0
    ds_write_b128 v115, v[180:183] offset:2048
    ds_write_b128 v115, v[188:191] offset:3072
    ds_write_b128 v115, v[196:199] offset:34816
    v_mfma_f32_16x16x32_bf16 v[44:47], v[252:255], v[92:95], v[44:47]
    v_cvt_pk_bf16_f32 v32, v32, v33
    v_cvt_pk_bf16_f32 v33, v34, v35
    v_cvt_pk_bf16_f32 v34, v36, v37
    v_cvt_pk_bf16_f32 v35, v38, v39
    v_cvt_pk_bf16_f32 v40, v40, v41
    v_cvt_pk_bf16_f32 v41, v42, v43
    v_mfma_f32_16x16x32_bf16 v[176:179], v[132:135], v[32:35], 0
    v_mfma_f32_16x16x32_bf16 v[184:187], v[140:143], v[32:35], 0
    v_cvt_pk_bf16_f32 v42, v44, v45
    v_cvt_pk_bf16_f32 v43, v46, v47
    ds_write_b128 v115, v[204:207] offset:35840
    v_mov_b32 v64, 0
    v_mfma_f32_16x16x32_bf16 v[192:195], v[148:151], v[40:43], 0
    v_mfma_f32_16x16x32_bf16 v[200:203], v[156:159], v[40:43], 0
    v_mov_b32 v65, 0
    v_mov_b32 v66, 0
    v_mov_b32 v67, 0
    v_mov_b32 v68, 0
    v_mov_b32 v69, 0
    v_mov_b32 v70, 0
    v_mov_b32 v71, 0
    v_mov_b32 v72, 0
    v_mov_b32 v80, 0
    v_mov_b32 v81, 0
    v_mov_b32 v82, 0
    v_mov_b32 v83, 0
    v_mov_b32 v84, 0
    v_mov_b32 v85, 0
    v_mov_b32 v86, 0
    v_mov_b32 v87, 0
    v_mov_b32 v88, 0
    v_and_b32 v13, 0x60, v121
    v_and_b32 v121, 0x1c, v121
    v_lshl_or_b32 v121, v13, 2, v121
    ds_write_b128 v115, v[176:179] offset:0
    ds_write_b128 v115, v[184:187] offset:1024
    ds_write_b128 v115, v[192:195] offset:32768
    ds_write_b128 v115, v[200:203] offset:33792
    s_waitcnt vmcnt(5)
    ds_write_b128 v114, v[208:211] offset:0
    s_waitcnt vmcnt(4)
    ds_write_b128 v114, v[212:215] offset:9216
    s_waitcnt lgkmcnt(0)
    s_barrier
    s_setprio 3
    ds_read_b128 v[96:99], v112
    ds_read_b128 v[100:103], v113
    ds_read_b128 v[160:163], v124 offset:0
    ds_read_b128 v[164:167], v124 offset:4096
    ds_read_b128 v[168:171], v124 offset:8192
    ds_read_b128 v[172:175], v124 offset:12288
    ds_read_b128 v[176:179], v124 offset:32768
    ds_read_b128 v[180:183], v124 offset:36864
    ds_read_b128 v[184:187], v124 offset:40960
    ds_read_b128 v[188:191], v124 offset:45056
    s_waitcnt vmcnt(2) lgkmcnt(9)
    v_mfma_f32_32x32x16_bf16 v[32:47], v[96:99], v[2:5], 0
    s_waitcnt lgkmcnt(4)
    v_add_f32 v160, v160, v164
    v_add_f32 v168, v168, v172
    v_add_f32 v161, v161, v165
    v_add_f32 v169, v169, v173
    v_add_f32 v162, v162, v166
    v_add_f32 v170, v170, v174
    v_add_f32 v163, v163, v167
    v_add_f32 v171, v171, v175
    v_add_f32 v160, v160, v168
    v_add_f32 v161, v161, v169
    v_add_f32 v162, v162, v170
    v_add_f32 v163, v163, v171
    buffer_store_dwordx4 v[160:163], v0, s[20:23], s51 offen sc1
    s_waitcnt lgkmcnt(0)
    v_add_f32 v176, v176, v180
    v_add_f32 v184, v184, v188
    v_add_f32 v177, v177, v181
    v_add_f32 v185, v185, v189
    v_add_f32 v178, v178, v182
    v_add_f32 v186, v186, v190
    v_add_f32 v179, v179, v183
    v_add_f32 v187, v187, v191
    v_add_f32 v176, v176, v184
    v_add_f32 v177, v177, v185
    v_add_f32 v178, v178, v186
    v_add_f32 v179, v179, v187
    s_add_u32 s51, s51, 65536
    buffer_store_dwordx4 v[176:179], v0, s[20:23], s51 offen sc1
    v_exp_f32 v32, v32
    v_exp_f32 v33, v33
    v_exp_f32 v34, v34
    v_exp_f32 v35, v35
    v_mfma_f32_32x32x16_bf16 v[48:63], v[96:99], v[6:9], 0
    v_exp_f32 v36, v36
    ds_read_b128 v[108:111], v113 offset:256
    ds_read_b128 v[96:99], v112 offset:4608
    ds_read_b128 v[104:107], v113 offset:4608
    v_exp_f32 v37, v37
    v_exp_f32 v38, v38
    v_exp_f32 v39, v39
    v_exp_f32 v40, v40
    v_exp_f32 v41, v41
    v_exp_f32 v42, v42
    v_exp_f32 v43, v43
    v_smfmac_f32_32x32x32_bf16 v[64:79], v[100:103], v[32:39], v10
    v_exp_f32 v44, v44
    v_exp_f32 v45, v45
    v_exp_f32 v46, v46
    v_exp_f32 v47, v47
    v_exp_f32 v48, v48
    v_exp_f32 v49, v49
    s_waitcnt lgkmcnt(0)
    v_smfmac_f32_32x32x32_bf16 v[64:79], v[108:111], v[40:47], v10
    v_exp_f32 v50, v50
    v_exp_f32 v51, v51
    v_mfma_f32_32x32x16_bf16 v[32:47], v[96:99], v[2:5], 0
    v_exp_f32 v52, v52
    v_exp_f32 v53, v53
    v_exp_f32 v54, v54
    v_exp_f32 v55, v55
    v_exp_f32 v56, v56
    v_exp_f32 v57, v57
    v_exp_f32 v58, v58
    v_exp_f32 v59, v59
    v_smfmac_f32_32x32x32_bf16 v[80:95], v[100:103], v[48:55], v10
    v_exp_f32 v60, v60
    v_exp_f32 v61, v61
    v_exp_f32 v62, v62
    v_exp_f32 v63, v63
    v_exp_f32 v32, v32
    v_exp_f32 v33, v33
    v_smfmac_f32_32x32x32_bf16 v[80:95], v[108:111], v[56:63], v10
    v_exp_f32 v34, v34
    v_exp_f32 v35, v35
    v_mfma_f32_32x32x16_bf16 v[48:63], v[96:99], v[6:9], 0
    v_exp_f32 v36, v36
    ds_read_b128 v[108:111], v113 offset:4864
    ds_read_b128 v[96:99], v112 offset:9216
    ds_read_b128 v[100:103], v113 offset:9216
    v_exp_f32 v37, v37
    v_exp_f32 v38, v38
    v_exp_f32 v39, v39
    v_exp_f32 v40, v40
    v_exp_f32 v41, v41
    v_exp_f32 v42, v42
    v_exp_f32 v43, v43
    v_smfmac_f32_32x32x32_bf16 v[64:79], v[104:107], v[32:39], v10
    v_exp_f32 v44, v44
    v_exp_f32 v45, v45
    v_exp_f32 v46, v46
    v_exp_f32 v47, v47
    v_exp_f32 v48, v48
    v_exp_f32 v49, v49
    s_waitcnt lgkmcnt(0)
    v_smfmac_f32_32x32x32_bf16 v[64:79], v[108:111], v[40:47], v10
    v_exp_f32 v50, v50
    v_exp_f32 v51, v51
    v_mfma_f32_32x32x16_bf16 v[32:47], v[96:99], v[2:5], 0
    v_exp_f32 v52, v52
    v_exp_f32 v53, v53
    s_mov_b64 exec, 0xf00
    buffer_load_dword v11, v127, s[20:23], 0 offen sc1
    s_mov_b64 exec, -1
    s_setprio 2
    v_exp_f32 v54, v54
    v_exp_f32 v55, v55
    v_exp_f32 v56, v56
    v_exp_f32 v57, v57
    v_exp_f32 v58, v58
    v_exp_f32 v59, v59
    v_smfmac_f32_32x32x32_bf16 v[80:95], v[104:107], v[48:55], v10
    v_exp_f32 v60, v60
    v_exp_f32 v61, v61
    v_exp_f32 v62, v62
    v_exp_f32 v63, v63
    v_exp_f32 v32, v32
    v_exp_f32 v33, v33
    v_smfmac_f32_32x32x32_bf16 v[80:95], v[108:111], v[56:63], v10
    v_exp_f32 v34, v34
    v_exp_f32 v35, v35
    v_mfma_f32_32x32x16_bf16 v[48:63], v[96:99], v[6:9], 0
    v_exp_f32 v36, v36
    ds_read_b128 v[108:111], v113 offset:9472
    ds_read_b128 v[96:99], v112 offset:13824
    ds_read_b128 v[104:107], v113 offset:13824
    v_exp_f32 v37, v37
    s_waitcnt vmcnt(4)
    ds_write_b128 v114, v[216:219] offset:18432
    v_exp_f32 v38, v38
    v_exp_f32 v39, v39
    v_exp_f32 v40, v40
    v_exp_f32 v41, v41
    v_exp_f32 v42, v42
    v_exp_f32 v43, v43
    v_smfmac_f32_32x32x32_bf16 v[64:79], v[100:103], v[32:39], v10
    v_exp_f32 v44, v44
    v_exp_f32 v45, v45
    v_exp_f32 v46, v46
    s_setprio 1
    v_exp_f32 v47, v47
    v_exp_f32 v48, v48
    v_exp_f32 v49, v49
    s_waitcnt lgkmcnt(0)
    v_smfmac_f32_32x32x32_bf16 v[64:79], v[108:111], v[40:47], v10
    v_exp_f32 v50, v50
    v_exp_f32 v51, v51
    v_mfma_f32_32x32x16_bf16 v[32:47], v[96:99], v[2:5], 0
    v_exp_f32 v52, v52
    v_exp_f32 v53, v53
    s_waitcnt vmcnt(3)
    ds_write_b128 v114, v[220:223] offset:27648
    v_exp_f32 v54, v54
    v_exp_f32 v55, v55
    v_exp_f32 v56, v56
    v_exp_f32 v57, v57
    v_exp_f32 v58, v58
    v_exp_f32 v59, v59
    v_smfmac_f32_32x32x32_bf16 v[80:95], v[100:103], v[48:55], v10
    s_setprio 0
    v_exp_f32 v60, v60
    v_exp_f32 v61, v61
    v_exp_f32 v62, v62
    v_exp_f32 v63, v63
    v_exp_f32 v32, v32
    v_exp_f32 v33, v33
    v_smfmac_f32_32x32x32_bf16 v[80:95], v[108:111], v[56:63], v10
    v_exp_f32 v34, v34
    s_waitcnt lgkmcnt(0)
    s_barrier
    s_setprio 3
    v_exp_f32 v35, v35
    v_mfma_f32_32x32x16_bf16 v[48:63], v[96:99], v[6:9], 0
    v_exp_f32 v36, v36
    ds_read_b128 v[108:111], v113 offset:14080
    ds_read_b128 v[96:99], v112 offset:18432
    ds_read_b128 v[100:103], v113 offset:18432
    v_exp_f32 v37, v37
    v_exp_f32 v38, v38
    v_exp_f32 v39, v39
    v_exp_f32 v40, v40
    v_exp_f32 v41, v41
    v_exp_f32 v42, v42
    v_exp_f32 v43, v43
    v_smfmac_f32_32x32x32_bf16 v[64:79], v[104:107], v[32:39], v10
    v_exp_f32 v44, v44
    v_exp_f32 v45, v45
    v_exp_f32 v46, v46
    v_exp_f32 v47, v47
    v_exp_f32 v48, v48
    v_exp_f32 v49, v49
    s_waitcnt lgkmcnt(0)
    v_smfmac_f32_32x32x32_bf16 v[64:79], v[108:111], v[40:47], v10
    v_exp_f32 v50, v50
    v_exp_f32 v51, v51
    v_mfma_f32_32x32x16_bf16 v[32:47], v[96:99], v[2:5], 0
    v_exp_f32 v52, v52
    v_exp_f32 v53, v53
    s_waitcnt vmcnt(0)
    v_cmp_gt_u32 vcc, 1, v11
    s_and_b32 s56, vcc_lo, 0xf00
    s_cbranch_scc1 L_qs34
L_qb35:
    v_exp_f32 v54, v54
    v_exp_f32 v55, v55
    v_exp_f32 v56, v56
    s_add_u32 s95, s63, 16384
    buffer_load_dwordx4 v[16:19], v0, s[20:23], s95 offen sc1
    v_exp_f32 v57, v57
    v_exp_f32 v58, v58
    v_exp_f32 v59, v59
    v_smfmac_f32_32x32x32_bf16 v[80:95], v[104:107], v[48:55], v10
    v_exp_f32 v60, v60
    v_exp_f32 v61, v61
    v_exp_f32 v62, v62
    v_exp_f32 v63, v63
    v_exp_f32 v32, v32
    v_exp_f32 v33, v33
    v_smfmac_f32_32x32x32_bf16 v[80:95], v[108:111], v[56:63], v10
    v_exp_f32 v34, v34
    v_exp_f32 v35, v35
    v_mfma_f32_32x32x16_bf16 v[48:63], v[96:99], v[6:9], 0
    v_exp_f32 v36, v36
    ds_read_b128 v[108:111], v113 offset:18688
    ds_read_b128 v[96:99], v112 offset:23040
    ds_read_b128 v[104:107], v113 offset:23040
    v_exp_f32 v37, v37
    s_add_u32 s95, s63, 20480
    buffer_load_dwordx4 v[20:23], v0, s[20:23], s95 offen sc1
    v_exp_f32 v38, v38
    v_exp_f32 v39, v39
    v_exp_f32 v40, v40
    v_exp_f32 v41, v41
    v_exp_f32 v42, v42
    v_exp_f32 v43, v43
    v_smfmac_f32_32x32x32_bf16 v[64:79], v[100:103], v[32:39], v10
    v_exp_f32 v44, v44
    v_exp_f32 v45, v45
    v_exp_f32 v46, v46
    v_exp_f32 v47, v47
    v_exp_f32 v48, v48
    v_exp_f32 v49, v49
    s_waitcnt lgkmcnt(0)
    v_smfmac_f32_32x32x32_bf16 v[64:79], v[108:111], v[40:47], v10
    v_exp_f32 v50, v50
    v_exp_f32 v51, v51
    v_mfma_f32_32x32x16_bf16 v[32:47], v[96:99], v[2:5], 0
    v_exp_f32 v52, v52
    v_exp_f32 v53, v53
    v_exp_f32 v54, v54
    v_exp_f32 v55, v55
    v_exp_f32 v56, v56
    v_exp_f32 v57, v57
    v_exp_f32 v58, v58
    v_exp_f32 v59, v59
    v_smfmac_f32_32x32x32_bf16 v[80:95], v[100:103], v[48:55], v10
    v_exp_f32 v60, v60
    v_exp_f32 v61, v61
    v_exp_f32 v62, v62
    v_exp_f32 v63, v63
    v_exp_f32 v32, v32
    v_exp_f32 v33, v33
    v_smfmac_f32_32x32x32_bf16 v[80:95], v[108:111], v[56:63], v10
    v_exp_f32 v34, v34
    s_waitcnt vmcnt(3) lgkmcnt(0)
    s_barrier
    s_cmp_lg_u32 s31, 0
    s_cbranch_scc1 L_w0_37
    s_lshl_b32 s56, s36, 8
    s_add_u32 s56, s56, 17829888
    v_mov_b32 v15, 0
    v_mov_b32 v13, 1
    s_mov_b64 exec, 1
    buffer_atomic_add v13, v15, s[20:23], s56 offen sc1
    s_mov_b64 exec, -1
L_w0_37:
    v_exp_f32 v35, v35
    v_mfma_f32_32x32x16_bf16 v[48:63], v[96:99], v[6:9], 0
    v_exp_f32 v36, v36
    ds_read_b128 v[108:111], v113 offset:23296
    ds_read_b128 v[96:99], v112 offset:27648
    ds_read_b128 v[100:103], v113 offset:27648
    v_exp_f32 v37, v37
    s_add_u32 s95, s63, 24576
    buffer_load_dwordx4 v[24:27], v0, s[20:23], s95 offen sc1
    v_exp_f32 v38, v38
    v_exp_f32 v39, v39
    v_exp_f32 v40, v40
    s_setprio 2
    v_exp_f32 v41, v41
    v_exp_f32 v42, v42
    v_exp_f32 v43, v43
    v_smfmac_f32_32x32x32_bf16 v[64:79], v[104:107], v[32:39], v10
    v_exp_f32 v44, v44
    v_exp_f32 v45, v45
    v_exp_f32 v46, v46
    v_exp_f32 v47, v47
    s_branch L_att
L_ty2:
    s_waitcnt lgkmcnt(8)
    v_mfma_f32_16x16x32_bf16 v[48:51], v[64:67], v[128:131], 0
    v_cvt_pk_bf16_f32 v16, v16, v17
    v_cvt_pk_bf16_f32 v17, v18, v19
    v_cvt_pk_bf16_f32 v18, v20, v21
    v_cvt_pk_bf16_f32 v19, v22, v23
    v_mfma_f32_16x16x32_bf16 v[52:55], v[64:67], v[132:135], 0
    ds_read_b64_tr_b16 v[64:65], v7 offset:49152
    ds_read_b64_tr_b16 v[66:67], v7 offset:49664
    v_cvt_pk_bf16_f32 v20, v32, v33
    v_cvt_pk_bf16_f32 v21, v34, v35
    v_permlane16_swap_b32 v16, v18
    v_permlane16_swap_b32 v17, v19
    s_add_u32 m0, s47, 55296
    s_nop 0
    buffer_load_dwordx4 v122, s[0:3], s94 offen lds
    v_mfma_f32_16x16x32_bf16 v[56:59], v[68:71], v[128:131], 0
    v_cvt_pk_bf16_f32 v22, v36, v37
    v_cvt_pk_bf16_f32 v23, v38, v39
    v_cvt_pk_bf16_f32 v24, v24, v25
    v_cvt_pk_bf16_f32 v25, v26, v27
    v_mfma_f32_16x16x32_bf16 v[60:63], v[68:71], v[132:135], 0
    ds_read_b64_tr_b16 v[68:69], v8 offset:49152
    ds_read_b64_tr_b16 v[70:71], v8 offset:49664
    v_permlane16_swap_b32 v20, v22
    v_permlane16_swap_b32 v21, v23
    v_cvt_pk_bf16_f32 v26, v28, v29
    v_cvt_pk_bf16_f32 v27, v30, v31
    v_mfma_f32_16x16x32_bf16 v[48:51], v[72:75], v[136:139], v[48:51]
    v_cvt_pk_bf16_f32 v28, v40, v41
    v_cvt_pk_bf16_f32 v29, v42, v43
    v_permlane16_swap_b32 v24, v26
    v_permlane16_swap_b32 v25, v27
    v_mfma_f32_16x16x32_bf16 v[52:55], v[72:75], v[140:143], v[52:55]
    ds_read_b64_tr_b16 v[72:73], v7 offset:57344
    ds_read_b64_tr_b16 v[74:75], v7 offset:57856
    v_cvt_pk_bf16_f32 v30, v44, v45
    v_cvt_pk_bf16_f32 v31, v46, v47
    s_nop 0
    s_nop 0
    v_mfma_f32_16x16x32_bf16 v[56:59], v[76:79], v[136:139], v[56:59]
    v_permlane16_swap_b32 v28, v30
    v_permlane16_swap_b32 v29, v31
    ds_write2_b32 v12, v124, v124 offset1:1
    ds_write2_b32 v12, v124, v124 offset0:2 offset1:3
    v_mfma_f32_16x16x32_bf16 v[60:63], v[76:79], v[140:143], v[60:63]
    ds_read_b64_tr_b16 v[76:77], v8 offset:57344
    ds_read_b64_tr_b16 v[78:79], v8 offset:57856
    ds_write_b32 v121, v96 offset:63488
    s_waitcnt lgkmcnt(11)
    v_mfma_f32_16x16x32_bf16 v[48:51], v[80:83], v[144:147], v[48:51]
    v_mfma_f32_16x16x32_bf16 v[52:55], v[80:83], v[148:151], v[52:55]
    ds_read_b64_tr_b16 v[80:81], v7 offset:50176
    ds_read_b64_tr_b16 v[82:83], v7 offset:50688
    v_mfma_f32_16x16x32_bf16 v[56:59], v[84:87], v[144:147], v[56:59]
    v_mfma_f32_16x16x32_bf16 v[60:63], v[84:87], v[148:151], v[60:63]
    ds_read_b64_tr_b16 v[84:85], v8 offset:50176
    ds_read_b64_tr_b16 v[86:87], v8 offset:50688
    v_mfma_f32_16x16x32_bf16 v[48:51], v[88:91], v[152:155], v[48:51]
    v_mfma_f32_16x16x32_bf16 v[52:55], v[88:91], v[156:159], v[52:55]
    ds_read_b64_tr_b16 v[88:89], v7 offset:58368
    ds_read_b64_tr_b16 v[90:91], v7 offset:58880
    v_mfma_f32_16x16x32_bf16 v[56:59], v[92:95], v[152:155], v[56:59]
    v_mfma_f32_16x16x32_bf16 v[60:63], v[92:95], v[156:159], v[60:63]
    ds_read_b64_tr_b16 v[92:93], v8 offset:58368
    ds_read_b64_tr_b16 v[94:95], v8 offset:58880
    s_waitcnt vmcnt(2) lgkmcnt(9)
    s_barrier
    v_mfma_f32_16x16x32_bf16 v[48:51], v[64:67], v[160:163], v[48:51]
    v_mov_b32 v144, 0
    v_mov_b32 v145, 0
    v_mov_b32 v148, 0
    v_mov_b32 v149, 0
    v_mfma_f32_16x16x32_bf16 v[52:55], v[64:67], v[164:167], v[52:55]
    ds_read_b64_tr_b16 v[64:65], v9 offset:0
    ds_read_b64_tr_b16 v[66:67], v9 offset:512
    v_mov_b32 v152, 0
    v_mov_b32 v153, 0
    v_mov_b32 v156, 0
    v_mov_b32 v157, 0
    v_mfma_f32_16x16x32_bf16 v[56:59], v[68:71], v[160:163], v[56:59]
    v_mfma_f32_16x16x32_bf16 v[60:63], v[68:71], v[164:167], v[60:63]
    ds_read_b64_tr_b16 v[68:69], v11 offset:0
    ds_read_b64_tr_b16 v[70:71], v11 offset:512
    s_cmp_lg_u32 s31, 1
    s_cbranch_scc1 L_gs38
    s_waitcnt lgkmcnt(15)
    s_mov_b32 exec_hi, 0
    buffer_store_dword v110, v121, s[20:23], s96 offen sc1
    s_mov_b32 exec_hi, -1
L_gs38:
    v_mfma_f32_16x16x32_bf16 v[48:51], v[72:75], v[168:171], v[48:51]
    v_mfma_f32_16x16x32_bf16 v[52:55], v[72:75], v[172:175], v[52:55]
    ds_read_b64_tr_b16 v[72:73], v9 offset:8192
    ds_read_b64_tr_b16 v[74:75], v9 offset:8704
    v_mfma_f32_16x16x32_bf16 v[56:59], v[76:79], v[168:171], v[56:59]
    v_mfma_f32_16x16x32_bf16 v[60:63], v[76:79], v[172:175], v[60:63]
    ds_read_b64_tr_b16 v[76:77], v11 offset:8192
    ds_read_b64_tr_b16 v[78:79], v11 offset:8704
    s_waitcnt lgkmcnt(8)
    v_mfma_f32_16x16x32_bf16 v[48:51], v[80:83], v[176:179], v[48:51]
    v_mfma_f32_16x16x32_bf16 v[52:55], v[80:83], v[180:183], v[52:55]
    ds_read_b64_tr_b16 v[80:81], v9 offset:1024
    ds_read_b64_tr_b16 v[82:83], v9 offset:1536
    v_mfma_f32_16x16x32_bf16 v[56:59], v[84:87], v[176:179], v[56:59]
    v_mfma_f32_16x16x32_bf16 v[60:63], v[84:87], v[180:183], v[60:63]
    ds_read_b64_tr_b16 v[84:85], v11 offset:1024
    ds_read_b64_tr_b16 v[86:87], v11 offset:1536
    v_mfma_f32_16x16x32_bf16 v[48:51], v[88:91], v[184:187], v[48:51]
    v_mfma_f32_16x16x32_bf16 v[52:55], v[88:91], v[188:191], v[52:55]
    ds_read_b64_tr_b16 v[88:89], v9 offset:9216
    ds_read_b64_tr_b16 v[90:91], v9 offset:9728
    v_mfma_f32_16x16x32_bf16 v[56:59], v[92:95], v[184:187], v[56:59]
    v_mfma_f32_16x16x32_bf16 v[60:63], v[92:95], v[188:191], v[60:63]
    ds_read_b64_tr_b16 v[92:93], v11 offset:9216
    ds_read_b64_tr_b16 v[94:95], v11 offset:9728
    s_waitcnt lgkmcnt(8)
    v_mfma_f32_16x16x32_bf16 v[48:51], v[64:67], v[192:195], v[48:51]
    v_mfma_f32_16x16x32_bf16 v[52:55], v[64:67], v[196:199], v[52:55]
    ds_read_b64_tr_b16 v[64:65], v9 offset:16384
    ds_read_b64_tr_b16 v[66:67], v9 offset:16896
    v_mfma_f32_16x16x32_bf16 v[56:59], v[68:71], v[192:195], v[56:59]
    v_mfma_f32_16x16x32_bf16 v[60:63], v[68:71], v[196:199], v[60:63]
    ds_read_b64_tr_b16 v[68:69], v11 offset:16384
    ds_read_b64_tr_b16 v[70:71], v11 offset:16896
    v_mfma_f32_16x16x32_bf16 v[48:51], v[72:75], v[200:203], v[48:51]
    v_mfma_f32_16x16x32_bf16 v[52:55], v[72:75], v[204:207], v[52:55]
    ds_read_b64_tr_b16 v[72:73], v9 offset:24576
    ds_read_b64_tr_b16 v[74:75], v9 offset:25088
    v_mfma_f32_16x16x32_bf16 v[56:59], v[76:79], v[200:203], v[56:59]
    v_mfma_f32_16x16x32_bf16 v[60:63], v[76:79], v[204:207], v[60:63]
    ds_read_b64_tr_b16 v[76:77], v11 offset:24576
    ds_read_b64_tr_b16 v[78:79], v11 offset:25088
    s_waitcnt lgkmcnt(8)
    v_mfma_f32_16x16x32_bf16 v[48:51], v[80:83], v[208:211], v[48:51]
    v_mfma_f32_16x16x32_bf16 v[52:55], v[80:83], v[212:215], v[52:55]
    ds_read_b64_tr_b16 v[80:81], v9 offset:17408
    ds_read_b64_tr_b16 v[82:83], v9 offset:17920
    v_mfma_f32_16x16x32_bf16 v[56:59], v[84:87], v[208:211], v[56:59]
    v_mfma_f32_16x16x32_bf16 v[60:63], v[84:87], v[212:215], v[60:63]
    ds_read_b64_tr_b16 v[84:85], v11 offset:17408
    ds_read_b64_tr_b16 v[86:87], v11 offset:17920
    v_mfma_f32_16x16x32_bf16 v[48:51], v[88:91], v[216:219], v[48:51]
    v_mfma_f32_16x16x32_bf16 v[52:55], v[88:91], v[220:223], v[52:55]
    ds_read_b64_tr_b16 v[88:89], v9 offset:25600
    ds_read_b64_tr_b16 v[90:91], v9 offset:26112
    v_mfma_f32_16x16x32_bf16 v[56:59], v[92:95], v[216:219], v[56:59]
    v_mfma_f32_16x16x32_bf16 v[60:63], v[92:95], v[220:223], v[60:63]
    ds_read_b64_tr_b16 v[92:93], v11 offset:25600
    ds_read_b64_tr_b16 v[94:95], v11 offset:26112
    s_waitcnt lgkmcnt(8)
    v_mfma_f32_16x16x32_bf16 v[48:51], v[64:67], v[224:227], v[48:51]
    v_mfma_f32_16x16x32_bf16 v[52:55], v[64:67], v[228:231], v[52:55]
    v_mfma_f32_16x16x32_bf16 v[56:59], v[68:71], v[224:227], v[56:59]
    v_mfma_f32_16x16x32_bf16 v[60:63], v[68:71], v[228:231], v[60:63]
    v_mfma_f32_16x16x32_bf16 v[48:51], v[72:75], v[232:235], v[48:51]
    v_mfma_f32_16x16x32_bf16 v[52:55], v[72:75], v[236:239], v[52:55]
    v_mfma_f32_16x16x32_bf16 v[56:59], v[76:79], v[232:235], v[56:59]
    v_mfma_f32_16x16x32_bf16 v[60:63], v[76:79], v[236:239], v[60:63]
    s_waitcnt lgkmcnt(0)
    s_waitcnt vmcnt(0)
    ds_read_b64_tr_b16 v[128:129], v125
    ds_read_b64_tr_b16 v[130:131], v125 offset:256
    v_mfma_f32_16x16x32_bf16 v[48:51], v[80:83], v[240:243], v[48:51]
    v_mfma_f32_16x16x32_bf16 v[52:55], v[80:83], v[244:247], v[52:55]
    v_mfma_f32_16x16x32_bf16 v[56:59], v[84:87], v[240:243], v[56:59]
    v_mfma_f32_16x16x32_bf16 v[60:63], v[84:87], v[244:247], v[60:63]
    v_mfma_f32_16x16x32_bf16 v[48:51], v[88:91], v[248:251], v[48:51]
    v_mfma_f32_16x16x32_bf16 v[52:55], v[88:91], v[252:255], v[52:55]
    v_mfma_f32_16x16x32_bf16 v[56:59], v[92:95], v[248:251], v[56:59]
    v_mfma_f32_16x16x32_bf16 v[60:63], v[92:95], v[252:255], v[60:63]
    v_mov_b32 v64, 0
    v_mov_b32 v65, 0
    v_mov_b32 v66, 0
    v_mov_b32 v67, 0
    v_mov_b32 v68, 0
    v_cvt_pk_bf16_f32 v48, v48, v49
    v_cvt_pk_bf16_f32 v49, v50, v51
    v_cvt_pk_bf16_f32 v50, v52, v53
    v_cvt_pk_bf16_f32 v51, v54, v55
    v_cvt_pk_bf16_f32 v56, v56, v57
    v_cvt_pk_bf16_f32 v57, v58, v59
    s_waitcnt vmcnt(1)
    v_cmp_eq_u32 vcc, 0, v111
    s_cmp_lg_u64 vcc, 0
    s_cbranch_scc1 L_fs41
L_fb42:
    s_mov_b64 exec, 0x3f
    buffer_load_dword v4, v127, s[20:23], 0 offen sc1
    s_mov_b64 exec, -1
    v_mfma_f32_16x16x32_bf16 v[192:195], v[98:101], v[48:51], 0
    v_mfma_f32_16x16x32_bf16 v[196:199], v[96:99], v[48:51], 0
    v_cvt_pk_bf16_f32 v58, v60, v61
    v_cvt_pk_bf16_f32 v59, v62, v63
    v_mov_b32 v69, 0
    v_mov_b32 v70, 0
    v_mfma_f32_16x16x32_bf16 v[200:203], v[102:105], v[56:59], 0
    v_mfma_f32_16x16x32_bf16 v[204:207], v[100:103], v[56:59], 0
    v_mov_b32 v71, 0
    v_exp_f32 v160, v192
    v_exp_f32 v164, -v192
    v_exp_f32 v161, v193
    v_exp_f32 v165, -v193
    v_exp_f32 v162, v194
    v_exp_f32 v166, -v194
    v_exp_f32 v163, v195
    v_exp_f32 v167, -v195
    v_exp_f32 v168, v196
    v_exp_f32 v172, -v196
    v_exp_f32 v169, v197
    v_exp_f32 v173, -v197
    v_exp_f32 v170, v198
    v_exp_f32 v174, -v198
    v_exp_f32 v171, v199
    v_exp_f32 v175, -v199
    v_exp_f32 v176, v200
    v_exp_f32 v180, -v200
    v_exp_f32 v177, v201
    v_exp_f32 v181, -v201
    v_exp_f32 v178, v202
    v_exp_f32 v182, -v202
    v_exp_f32 v179, v203
    v_exp_f32 v183, -v203
    v_exp_f32 v184, v204
    v_exp_f32 v188, -v204
    v_exp_f32 v185, v205
    v_exp_f32 v189, -v205
    v_exp_f32 v186, v206
    v_exp_f32 v190, -v206
    v_exp_f32 v187, v207
    v_exp_f32 v191, -v207
    v_max3_f32 v13, abs(v192), abs(v193), abs(v194)
    v_max3_f32 v15, abs(v195), abs(v196), abs(v197)
    v_max3_f32 v13, v13, abs(v198), abs(v199)
    v_max3_f32 v15, v15, abs(v200), abs(v201)
    v_max3_f32 v13, v13, abs(v202), abs(v203)
    v_max3_f32 v15, v15, abs(v204), abs(v205)
    v_max3_f32 v13, v13, abs(v206), abs(v207)
    v_max_f32 v13, v13, v15
    v_cmp_nlt_f32 vcc, v13, s50
    s_cmp_lg_u64 vcc, 0
    s_cbranch_scc1 L_phs39
L_phj40:
    v_smfmac_f32_16x16x64_bf16 v[144:147], v[106:109], v[160:167], v10
    v_smfmac_f32_16x16x64_bf16 v[148:151], v[106:109], v[168:175], v10
    v_smfmac_f32_16x16x64_bf16 v[152:155], v[106:109], v[176:183], v10
    v_smfmac_f32_16x16x64_bf16 v[156:159], v[106:109], v[184:191], v10
    s_waitcnt vmcnt(0)
    v_cmp_gt_u32 vcc, 1, v4
    s_and_b32 s56, vcc_lo, 0x3f
    s_cbranch_scc1 L_qs45
L_qb46:
    buffer_load_dwordx4 v[208:211], v0, s[20:23], s63 offen sc1
    s_add_u32 s95, s63, 4096
    buffer_load_dwordx4 v[212:215], v0, s[20:23], s95 offen sc1
    v_rcp_f32 v144, v144
    v_rcp_f32 v145, v145
    buffer_load_dwordx4 v[2:5], v0, s[20:23], s34 offen sc1
    buffer_load_dwordx4 v[6:9], v0, s[20:23], s29 offen sc1
    v_rcp_f32 v148, v148
    v_rcp_f32 v149, v149
    s_add_u32 s95, s63, 8192
    buffer_load_dwordx4 v[216:219], v0, s[20:23], s95 offen sc1
    s_add_u32 s95, s63, 12288
    buffer_load_dwordx4 v[220:223], v0, s[20:23], s95 offen sc1
    v_rcp_f32 v152, v152
    v_rcp_f32 v153, v153
    v_rcp_f32 v156, v156
    v_rcp_f32 v157, v157
    v_mul_f32 v160, v160, v144
    v_mul_f32 v161, v161, v144
    v_mul_f32 v162, v162, v144
    v_mul_f32 v163, v163, v144
    v_mul_f32 v164, v164, v145
    v_mul_f32 v165, v165, v145
    v_mul_f32 v166, v166, v145
    v_mul_f32 v167, v167, v145
    v_cvt_pk_bf16_f32 v160, v160, v161
    v_cvt_pk_bf16_f32 v161, v162, v163
    v_cvt_pk_bf16_f32 v162, v164, v165
    v_cvt_pk_bf16_f32 v163, v166, v167
    v_mul_f32 v168, v168, v148
    v_mul_f32 v169, v169, v148
    v_mul_f32 v170, v170, v148
    v_mul_f32 v171, v171, v148
    v_mul_f32 v172, v172, v149
    v_mul_f32 v173, v173, v149
    v_mul_f32 v174, v174, v149
    v_mul_f32 v175, v175, v149
    v_cvt_pk_bf16_f32 v168, v168, v169
    v_cvt_pk_bf16_f32 v169, v170, v171
    v_cvt_pk_bf16_f32 v170, v172, v173
    v_cvt_pk_bf16_f32 v171, v174, v175
    v_mul_f32 v176, v176, v152
    v_mul_f32 v177, v177, v152
    v_mul_f32 v178, v178, v152
    v_mul_f32 v179, v179, v152
    v_mul_f32 v180, v180, v153
    v_mul_f32 v181, v181, v153
    v_mul_f32 v182, v182, v153
    v_mul_f32 v183, v183, v153
    v_cvt_pk_bf16_f32 v176, v176, v177
    v_cvt_pk_bf16_f32 v177, v178, v179
    v_cvt_pk_bf16_f32 v178, v180, v181
    v_cvt_pk_bf16_f32 v179, v182, v183
    v_mul_f32 v184, v184, v156
    v_mul_f32 v185, v185, v156
    v_mul_f32 v186, v186, v156
    v_mul_f32 v187, v187, v156
    v_mul_f32 v188, v188, v157
    v_mul_f32 v189, v189, v157
    v_mul_f32 v190, v190, v157
    v_mul_f32 v191, v191, v157
    v_cvt_pk_bf16_f32 v184, v184, v185
    v_cvt_pk_bf16_f32 v185, v186, v187
    v_cvt_pk_bf16_f32 v186, v188, v189
    v_cvt_pk_bf16_f32 v187, v190, v191
    v_mov_b32 v72, 0
    s_waitcnt vmcnt(5)
    ds_write_b128 v114, v[208:211] offset:0
    s_waitcnt vmcnt(4)
    ds_write_b128 v114, v[212:215] offset:9216
    s_waitcnt lgkmcnt(0)
    s_barrier
    s_setprio 3
    ds_read_b128 v[96:99], v112
    ds_read_b128 v[100:103], v113
    s_waitcnt vmcnt(2) lgkmcnt(0)
    v_mfma_f32_32x32x16_bf16 v[32:47], v[96:99], v[2:5], 0
    v_mov_b32 v80, 0
    v_mov_b32 v81, 0
    v_mov_b32 v82, 0
    v_mov_b32 v83, 0
    v_mov_b32 v84, 0
    v_mov_b32 v85, 0
    v_mov_b32 v86, 0
    v_mov_b32 v87, 0
    v_mov_b32 v88, 0
    v_and_b32 v13, 0x60, v121
    v_and_b32 v121, 0x1c, v121
    v_lshl_or_b32 v121, v13, 2, v121
    v_exp_f32 v32, v32
    v_exp_f32 v33, v33
    v_exp_f32 v34, v34
    v_exp_f32 v35, v35
    v_mfma_f32_32x32x16_bf16 v[48:63], v[96:99], v[6:9], 0
    v_exp_f32 v36, v36
    ds_read_b128 v[108:111], v113 offset:256
    ds_read_b128 v[96:99], v112 offset:4608
    ds_read_b128 v[104:107], v113 offset:4608
    v_exp_f32 v37, v37
    s_add_u32 s54, s53, 2097152
    buffer_store_dwordx4 v[16:19], v0, s[20:23], s54 offen sc1
    v_exp_f32 v38, v38
    v_exp_f32 v39, v39
    v_exp_f32 v40, v40
    s_add_u32 s54, s53, 4194304
    buffer_store_dwordx4 v[20:23], v0, s[20:23], s54 offen sc1
    v_exp_f32 v41, v41
    v_exp_f32 v42, v42
    v_exp_f32 v43, v43
    v_smfmac_f32_32x32x32_bf16 v[64:79], v[100:103], v[32:39], v10
    v_exp_f32 v44, v44
    v_exp_f32 v45, v45
    v_exp_f32 v46, v46
    v_exp_f32 v47, v47
    v_exp_f32 v48, v48
    v_exp_f32 v49, v49
    s_waitcnt lgkmcnt(0)
    v_smfmac_f32_32x32x32_bf16 v[64:79], v[108:111], v[40:47], v10
    v_exp_f32 v50, v50
    v_exp_f32 v51, v51
    v_mfma_f32_32x32x16_bf16 v[32:47], v[96:99], v[2:5], 0
    v_exp_f32 v52, v52
    v_exp_f32 v53, v53
    s_add_u32 s54, s53, 2162688
    buffer_store_dwordx4 v[24:27], v0, s[20:23], s54 offen sc1
    v_exp_f32 v54, v54
    v_exp_f32 v55, v55
    v_exp_f32 v56, v56
    s_add_u32 s54, s53, 4259840
    buffer_store_dwordx4 v[28:31], v0, s[20:23], s54 offen sc1
    v_exp_f32 v57, v57
    v_exp_f32 v58, v58
    v_exp_f32 v59, v59
    v_smfmac_f32_32x32x32_bf16 v[80:95], v[100:103], v[48:55], v10
    v_exp_f32 v60, v60
    v_exp_f32 v61, v61
    v_exp_f32 v62, v62
    v_exp_f32 v63, v63
    v_exp_f32 v32, v32
    v_exp_f32 v33, v33
    v_smfmac_f32_32x32x32_bf16 v[80:95], v[108:111], v[56:63], v10
    v_exp_f32 v34, v34
    v_exp_f32 v35, v35
    v_mfma_f32_32x32x16_bf16 v[48:63], v[96:99], v[6:9], 0
    v_exp_f32 v36, v36
    ds_read_b128 v[108:111], v113 offset:4864
    ds_read_b128 v[96:99], v112 offset:9216
    ds_read_b128 v[100:103], v113 offset:9216
    v_exp_f32 v37, v37
    buffer_store_dwordx4 v[160:163], v0, s[20:23], s52 offen offset:0 sc1
    v_exp_f32 v38, v38
    v_exp_f32 v39, v39
    v_exp_f32 v40, v40
    buffer_store_dwordx4 v[168:171], v0, s[20:23], s52 offen offset:1024 sc1
    v_exp_f32 v41, v41
    v_exp_f32 v42, v42
    v_exp_f32 v43, v43
    v_smfmac_f32_32x32x32_bf16 v[64:79], v[104:107], v[32:39], v10
    v_exp_f32 v44, v44
    v_exp_f32 v45, v45
    v_exp_f32 v46, v46
    v_exp_f32 v47, v47
    v_exp_f32 v48, v48
    v_exp_f32 v49, v49
    s_waitcnt lgkmcnt(0)
    v_smfmac_f32_32x32x32_bf16 v[64:79], v[108:111], v[40:47], v10
    v_exp_f32 v50, v50
    v_exp_f32 v51, v51
    v_mfma_f32_32x32x16_bf16 v[32:47], v[96:99], v[2:5], 0
    v_exp_f32 v52, v52
    v_exp_f32 v53, v53
    s_mov_b64 exec, 0xf00
    buffer_load_dword v11, v127, s[20:23], 0 offen sc1
    s_mov_b64 exec, -1
    s_setprio 2
    v_exp_f32 v54, v54
    v_exp_f32 v55, v55
    v_exp_f32 v56, v56
    s_add_u32 s52, s52, 131072
    buffer_store_dwordx4 v[176:179], v0, s[20:23], s52 offen offset:0 sc1
    v_exp_f32 v57, v57
    v_exp_f32 v58, v58
    v_exp_f32 v59, v59
    v_smfmac_f32_32x32x32_bf16 v[80:95], v[104:107], v[48:55], v10
    v_exp_f32 v60, v60
    v_exp_f32 v61, v61
    v_exp_f32 v62, v62
    v_exp_f32 v63, v63
    v_exp_f32 v32, v32
    v_exp_f32 v33, v33
    v_smfmac_f32_32x32x32_bf16 v[80:95], v[108:111], v[56:63], v10
    v_exp_f32 v34, v34
    v_exp_f32 v35, v35
    v_mfma_f32_32x32x16_bf16 v[48:63], v[96:99], v[6:9], 0
    v_exp_f32 v36, v36
    ds_read_b128 v[108:111], v113 offset:9472
    ds_read_b128 v[96:99], v112 offset:13824
    ds_read_b128 v[104:107], v113 offset:13824
    v_exp_f32 v37, v37
    s_waitcnt vmcnt(9)
    ds_write_b128 v114, v[216:219] offset:18432
    v_exp_f32 v38, v38
    v_exp_f32 v39, v39
    v_exp_f32 v40, v40
    buffer_store_dwordx4 v[184:187], v0, s[20:23], s52 offen offset:1024 sc1
    v_exp_f32 v41, v41
    v_exp_f32 v42, v42
    v_exp_f32 v43, v43
    v_smfmac_f32_32x32x32_bf16 v[64:79], v[100:103], v[32:39], v10
    v_exp_f32 v44, v44
    v_exp_f32 v45, v45
    v_exp_f32 v46, v46
    s_setprio 1
    v_exp_f32 v47, v47
    v_exp_f32 v48, v48
    v_exp_f32 v49, v49
    s_waitcnt lgkmcnt(0)
    v_smfmac_f32_32x32x32_bf16 v[64:79], v[108:111], v[40:47], v10
    v_exp_f32 v50, v50
    v_exp_f32 v51, v51
    v_mfma_f32_32x32x16_bf16 v[32:47], v[96:99], v[2:5], 0
    v_exp_f32 v52, v52
    v_exp_f32 v53, v53
    s_waitcnt vmcnt(9)
    ds_write_b128 v114, v[220:223] offset:27648
    v_exp_f32 v54, v54
    v_exp_f32 v55, v55
    v_exp_f32 v56, v56
    buffer_store_dwordx4 v[128:131], v126, s[20:23], s99 offen sc1
    v_exp_f32 v57, v57
    v_exp_f32 v58, v58
    v_exp_f32 v59, v59
    v_smfmac_f32_32x32x32_bf16 v[80:95], v[100:103], v[48:55], v10
    s_setprio 0
    v_exp_f32 v60, v60
    v_exp_f32 v61, v61
    v_exp_f32 v62, v62
    v_exp_f32 v63, v63
    v_exp_f32 v32, v32
    v_exp_f32 v33, v33
    v_smfmac_f32_32x32x32_bf16 v[80:95], v[108:111], v[56:63], v10
    v_exp_f32 v34, v34
    s_waitcnt lgkmcnt(0)
    s_barrier
    s_setprio 3
    v_exp_f32 v35, v35
    v_mfma_f32_32x32x16_bf16 v[48:63], v[96:99], v[6:9], 0
    v_exp_f32 v36, v36
    ds_read_b128 v[108:111], v113 offset:14080
    ds_read_b128 v[96:99], v112 offset:18432
    ds_read_b128 v[100:103], v113 offset:18432
    v_exp_f32 v37, v37
    v_exp_f32 v38, v38
    v_exp_f32 v39, v39
    v_exp_f32 v40, v40
    v_exp_f32 v41, v41
    v_exp_f32 v42, v42
    v_exp_f32 v43, v43
    v_smfmac_f32_32x32x32_bf16 v[64:79], v[104:107], v[32:39], v10
    v_exp_f32 v44, v44
    v_exp_f32 v45, v45
    v_exp_f32 v46, v46
    v_exp_f32 v47, v47
    v_exp_f32 v48, v48
    v_exp_f32 v49, v49
    s_waitcnt lgkmcnt(0)
    v_smfmac_f32_32x32x32_bf16 v[64:79], v[108:111], v[40:47], v10
    v_exp_f32 v50, v50
    v_exp_f32 v51, v51
    v_mfma_f32_32x32x16_bf16 v[32:47], v[96:99], v[2:5], 0
    v_exp_f32 v52, v52
    v_exp_f32 v53, v53
    s_waitcnt vmcnt(3)
    v_cmp_gt_u32 vcc, 1, v11
    s_and_b32 s56, vcc_lo, 0xf00
    s_cbranch_scc1 L_qs48
L_qb49:
    v_exp_f32 v54, v54
    v_exp_f32 v55, v55
    v_exp_f32 v56, v56
    s_add_u32 s95, s63, 16384
    buffer_load_dwordx4 v[16:19], v0, s[20:23], s95 offen sc1
    v_exp_f32 v57, v57
    v_exp_f32 v58, v58
    v_exp_f32 v59, v59
    v_smfmac_f32_32x32x32_bf16 v[80:95], v[104:107], v[48:55], v10
    v_exp_f32 v60, v60
    v_exp_f32 v61, v61
    v_exp_f32 v62, v62
    v_exp_f32 v63, v63
    v_exp_f32 v32, v32
    v_exp_f32 v33, v33
    v_smfmac_f32_32x32x32_bf16 v[80:95], v[108:111], v[56:63], v10
    v_exp_f32 v34, v34
    v_exp_f32 v35, v35
    v_mfma_f32_32x32x16_bf16 v[48:63], v[96:99], v[6:9], 0
    v_exp_f32 v36, v36
    ds_read_b128 v[108:111], v113 offset:18688
    ds_read_b128 v[96:99], v112 offset:23040
    ds_read_b128 v[104:107], v113 offset:23040
    v_exp_f32 v37, v37
    s_add_u32 s95, s63, 20480
    buffer_load_dwordx4 v[20:23], v0, s[20:23], s95 offen sc1
    v_exp_f32 v38, v38
    v_exp_f32 v39, v39
    v_exp_f32 v40, v40
    v_exp_f32 v41, v41
    v_exp_f32 v42, v42
    v_exp_f32 v43, v43
    v_smfmac_f32_32x32x32_bf16 v[64:79], v[100:103], v[32:39], v10
    v_exp_f32 v44, v44
    v_exp_f32 v45, v45
    v_exp_f32 v46, v46
    v_exp_f32 v47, v47
    v_exp_f32 v48, v48
    v_exp_f32 v49, v49
    s_waitcnt lgkmcnt(0)
    v_smfmac_f32_32x32x32_bf16 v[64:79], v[108:111], v[40:47], v10
    v_exp_f32 v50, v50
    v_exp_f32 v51, v51
    v_mfma_f32_32x32x16_bf16 v[32:47], v[96:99], v[2:5], 0
    v_exp_f32 v52, v52
    v_exp_f32 v53, v53
    v_exp_f32 v54, v54
    v_exp_f32 v55, v55
    v_exp_f32 v56, v56
    v_exp_f32 v57, v57
    v_exp_f32 v58, v58
    v_exp_f32 v59, v59
    v_smfmac_f32_32x32x32_bf16 v[80:95], v[100:103], v[48:55], v10
    v_exp_f32 v60, v60
    v_exp_f32 v61, v61
    v_exp_f32 v62, v62
    v_exp_f32 v63, v63
    v_exp_f32 v32, v32
    v_exp_f32 v33, v33
    v_smfmac_f32_32x32x32_bf16 v[80:95], v[108:111], v[56:63], v10
    v_exp_f32 v34, v34
    s_waitcnt vmcnt(2) lgkmcnt(0)
    s_barrier
    s_cmp_lg_u32 s31, 0
    s_cbranch_scc1 L_w0_51
    s_lshl_b32 s56, s36, 8
    s_add_u32 s56, s56, 17829888
    v_mov_b32 v15, 0
    v_mov_b32 v13, 1
    s_mov_b64 exec, 1
    buffer_atomic_add v13, v15, s[20:23], s56 offen sc1
    s_mov_b64 exec, -1
L_w0_51:
    v_exp_f32 v35, v35
    v_mfma_f32_32x32x16_bf16 v[48:63], v[96:99], v[6:9], 0
    v_exp_f32 v36, v36
    ds_read_b128 v[108:111], v113 offset:23296
    ds_read_b128 v[96:99], v112 offset:27648
    ds_read_b128 v[100:103], v113 offset:27648
    v_exp_f32 v37, v37
    s_add_u32 s95, s63, 24576
    buffer_load_dwordx4 v[24:27], v0, s[20:23], s95 offen sc1
    v_exp_f32 v38, v38
    v_exp_f32 v39, v39
    v_exp_f32 v40, v40
    s_setprio 2
    v_exp_f32 v41, v41
    v_exp_f32 v42, v42
    v_exp_f32 v43, v43
    v_smfmac_f32_32x32x32_bf16 v[64:79], v[104:107], v[32:39], v10
    v_exp_f32 v44, v44
    v_exp_f32 v45, v45
    v_exp_f32 v46, v46
    v_exp_f32 v47, v47
L_att:
    v_exp_f32 v48, v48
    v_exp_f32 v49, v49
    s_waitcnt lgkmcnt(0)
    v_smfmac_f32_32x32x32_bf16 v[64:79], v[108:111], v[40:47], v10
    v_exp_f32 v50, v50
    v_exp_f32 v51, v51
    v_mfma_f32_32x32x16_bf16 v[32:47], v[96:99], v[2:5], 0
    v_exp_f32 v52, v52
    v_exp_f32 v53, v53
    s_waitcnt vmcnt(2)
    ds_write_b128 v114, v[16:19] offset:36864
    v_exp_f32 v54, v54
    v_exp_f32 v55, v55
    v_exp_f32 v56, v56
    s_add_u32 s95, s63, 28672
    buffer_load_dwordx4 v[28:31], v0, s[20:23], s95 offen sc1
    v_exp_f32 v57, v57
    v_exp_f32 v58, v58
    v_exp_f32 v59, v59
    v_smfmac_f32_32x32x32_bf16 v[80:95], v[104:107], v[48:55], v10
    v_exp_f32 v60, v60
    v_exp_f32 v61, v61
    v_exp_f32 v62, v62
    v_exp_f32 v63, v63
    v_exp_f32 v32, v32
    v_exp_f32 v33, v33
    v_smfmac_f32_32x32x32_bf16 v[80:95], v[108:111], v[56:63], v10
    v_exp_f32 v34, v34
    v_exp_f32 v35, v35
    v_mfma_f32_32x32x16_bf16 v[48:63], v[96:99], v[6:9], 0
    v_exp_f32 v36, v36
    ds_read_b128 v[108:111], v113 offset:27904
    ds_read_b128 v[96:99], v112 offset:32256
    ds_read_b128 v[104:107], v113 offset:32256
    v_exp_f32 v37, v37
    s_waitcnt vmcnt(2)
    ds_write_b128 v114, v[20:23] offset:46080
    v_exp_f32 v38, v38
    v_exp_f32 v39, v39
    v_exp_f32 v40, v40
    v_mov_b32 v128, 0xff81ff81
    v_mov_b32 v129, 0xff81ff81
    v_mov_b32 v130, 0xff81ff81
    v_mov_b32 v131, 0xff81ff81
    buffer_store_dwordx4 v[128:131], v0, s[20:23], s97 offen sc1
    s_setprio 1
    v_exp_f32 v41, v41
    v_exp_f32 v42, v42
    v_exp_f32 v43, v43
    v_smfmac_f32_32x32x32_bf16 v[64:79], v[100:103], v[32:39], v10
    v_exp_f32 v44, v44
    v_exp_f32 v45, v45
    v_exp_f32 v46, v46
    v_exp_f32 v47, v47
    v_exp_f32 v48, v48
    v_exp_f32 v49, v49
    s_waitcnt lgkmcnt(0)
    v_smfmac_f32_32x32x32_bf16 v[64:79], v[108:111], v[40:47], v10
    v_exp_f32 v50, v50
    v_exp_f32 v51, v51
    v_mfma_f32_32x32x16_bf16 v[32:47], v[96:99], v[2:5], 0
    v_exp_f32 v52, v52
    v_exp_f32 v53, v53
    v_exp_f32 v54, v54
    v_exp_f32 v55, v55
    v_exp_f32 v56, v56
    v_exp_f32 v57, v57
    s_setprio 0
    v_exp_f32 v58, v58
    v_exp_f32 v59, v59
    v_smfmac_f32_32x32x32_bf16 v[80:95], v[100:103], v[48:55], v10
    v_exp_f32 v60, v60
    v_exp_f32 v61, v61
    v_exp_f32 v62, v62
    v_exp_f32 v63, v63
    v_exp_f32 v32, v32
    v_exp_f32 v33, v33
    v_smfmac_f32_32x32x32_bf16 v[80:95], v[108:111], v[56:63], v10
    v_exp_f32 v34, v34
    s_waitcnt lgkmcnt(0)
    s_barrier
    s_setprio 3
    v_exp_f32 v35, v35
    v_mfma_f32_32x32x16_bf16 v[48:63], v[96:99], v[6:9], 0
    v_exp_f32 v36, v36
    ds_read_b128 v[108:111], v113 offset:32512
    ds_read_b128 v[96:99], v112 offset:36864
    ds_read_b128 v[100:103], v113 offset:36864
    v_exp_f32 v37, v37
    v_exp_f32 v38, v38
    v_exp_f32 v39, v39
    v_exp_f32 v40, v40
    v_exp_f32 v41, v41
    v_exp_f32 v42, v42
    v_exp_f32 v43, v43
    v_smfmac_f32_32x32x32_bf16 v[64:79], v[104:107], v[32:39], v10
    v_exp_f32 v44, v44
    v_exp_f32 v45, v45
    v_exp_f32 v46, v46
    v_exp_f32 v47, v47
    v_exp_f32 v48, v48
    v_exp_f32 v49, v49
    s_waitcnt lgkmcnt(0)
    v_smfmac_f32_32x32x32_bf16 v[64:79], v[108:111], v[40:47], v10
    v_exp_f32 v50, v50
    v_exp_f32 v51, v51
    v_mfma_f32_32x32x16_bf16 v[32:47], v[96:99], v[2:5], 0
    v_exp_f32 v52, v52
    v_exp_f32 v53, v53
    v_exp_f32 v54, v54
    v_exp_f32 v55, v55
    v_exp_f32 v56, v56
    v_exp_f32 v57, v57
    v_exp_f32 v58, v58
    v_exp_f32 v59, v59
    v_smfmac_f32_32x32x32_bf16 v[80:95], v[104:107], v[48:55], v10
    v_exp_f32 v60, v60
    v_exp_f32 v61, v61
    v_exp_f32 v62, v62
    v_exp_f32 v63, v63
    v_exp_f32 v32, v32
    v_exp_f32 v33, v33
    v_smfmac_f32_32x32x32_bf16 v[80:95], v[108:111], v[56:63], v10
    v_exp_f32 v34, v34
    v_exp_f32 v35, v35
    v_mfma_f32_32x32x16_bf16 v[48:63], v[96:99], v[6:9], 0
    v_exp_f32 v36, v36
    ds_read_b128 v[108:111], v113 offset:37120
    ds_read_b128 v[96:99], v112 offset:41472
    ds_read_b128 v[104:107], v113 offset:41472
    v_exp_f32 v37, v37
    v_exp_f32 v38, v38
    v_exp_f32 v39, v39
    v_exp_f32 v40, v40
    v_exp_f32 v41, v41
    v_exp_f32 v42, v42
    v_exp_f32 v43, v43
    v_smfmac_f32_32x32x32_bf16 v[64:79], v[100:103], v[32:39], v10
    v_exp_f32 v44, v44
    v_exp_f32 v45, v45
    v_exp_f32 v46, v46
    v_exp_f32 v47, v47
    v_exp_f32 v48, v48
    v_exp_f32 v49, v49
    s_waitcnt lgkmcnt(0)
    v_smfmac_f32_32x32x32_bf16 v[64:79], v[108:111], v[40:47], v10
    v_exp_f32 v50, v50
    v_exp_f32 v51, v51
    v_mfma_f32_32x32x16_bf16 v[32:47], v[96:99], v[2:5], 0
    v_exp_f32 v52, v52
    v_exp_f32 v53, v53
    s_mov_b32 s57, 17829888
    buffer_load_dword v159, v120, s[20:23], s57 offen sc1
    v_exp_f32 v54, v54
    v_exp_f32 v55, v55
    v_exp_f32 v56, v56
    v_exp_f32 v57, v57
    v_exp_f32 v58, v58
    v_exp_f32 v59, v59
    v_smfmac_f32_32x32x32_bf16 v[80:95], v[100:103], v[48:55], v10
    v_exp_f32 v60, v60
    v_exp_f32 v61, v61
    v_exp_f32 v62, v62
    v_exp_f32 v63, v63
    v_exp_f32 v32, v32
    v_exp_f32 v33, v33
    v_smfmac_f32_32x32x32_bf16 v[80:95], v[108:111], v[56:63], v10
    v_exp_f32 v34, v34
    v_exp_f32 v35, v35
    v_mfma_f32_32x32x16_bf16 v[48:63], v[96:99], v[6:9], 0
    v_exp_f32 v36, v36
    ds_read_b128 v[108:111], v113 offset:41728
    ds_read_b128 v[96:99], v112 offset:46080
    ds_read_b128 v[100:103], v113 offset:46080
    v_exp_f32 v37, v37
    v_exp_f32 v38, v38
    v_exp_f32 v39, v39
    v_exp_f32 v40, v40
    s_setprio 2
    v_exp_f32 v41, v41
    v_exp_f32 v42, v42
    v_exp_f32 v43, v43
    v_smfmac_f32_32x32x32_bf16 v[64:79], v[104:107], v[32:39], v10
    v_exp_f32 v44, v44
    v_exp_f32 v45, v45
    v_exp_f32 v46, v46
    v_exp_f32 v47, v47
    v_exp_f32 v48, v48
    v_exp_f32 v49, v49
    s_waitcnt lgkmcnt(0)
    v_smfmac_f32_32x32x32_bf16 v[64:79], v[108:111], v[40:47], v10
    v_exp_f32 v50, v50
    v_exp_f32 v51, v51
    v_mfma_f32_32x32x16_bf16 v[32:47], v[96:99], v[2:5], 0
    v_exp_f32 v52, v52
    v_exp_f32 v53, v53
    s_waitcnt vmcnt(3)
    ds_write_b128 v114, v[24:27] offset:0
    v_exp_f32 v54, v54
    v_exp_f32 v55, v55
    v_exp_f32 v56, v56
    v_exp_f32 v57, v57
    v_exp_f32 v58, v58
    v_exp_f32 v59, v59
    v_smfmac_f32_32x32x32_bf16 v[80:95], v[104:107], v[48:55], v10
    v_exp_f32 v60, v60
    v_exp_f32 v61, v61
    v_exp_f32 v62, v62
    v_exp_f32 v63, v63
    v_exp_f32 v32, v32
    v_exp_f32 v33, v33
    v_smfmac_f32_32x32x32_bf16 v[80:95], v[108:111], v[56:63], v10
    v_exp_f32 v34, v34
    v_exp_f32 v35, v35
    v_mfma_f32_32x32x16_bf16 v[48:63], v[96:99], v[6:9], 0
    v_exp_f32 v36, v36
    ds_read_b128 v[108:111], v113 offset:46336
    ds_read_b128 v[96:99], v112 offset:50688
    ds_read_b128 v[104:107], v113 offset:50688
    v_exp_f32 v37, v37
    s_waitcnt vmcnt(2)
    ds_write_b128 v114, v[28:31] offset:9216
    v_exp_f32 v38, v38
    v_exp_f32 v39, v39
    v_exp_f32 v40, v40
    s_setprio 1
    v_exp_f32 v41, v41
    v_exp_f32 v42, v42
    v_exp_f32 v43, v43
    v_smfmac_f32_32x32x32_bf16 v[64:79], v[100:103], v[32:39], v10
    v_exp_f32 v44, v44
    v_exp_f32 v45, v45
    v_exp_f32 v46, v46
    v_exp_f32 v47, v47
    v_exp_f32 v48, v48
    v_exp_f32 v49, v49
    s_waitcnt lgkmcnt(0)
    v_smfmac_f32_32x32x32_bf16 v[64:79], v[108:111], v[40:47], v10
    v_exp_f32 v50, v50
    v_exp_f32 v51, v51
    v_mfma_f32_32x32x16_bf16 v[32:47], v[96:99], v[2:5], 0
    v_exp_f32 v52, v52
    v_exp_f32 v53, v53
    s_waitcnt vmcnt(0)
    v_cmp_gt_u32 vcc, 32, v159
    s_cmp_eq_u64 vcc, 0
    s_cbranch_scc1 L_pbk1
    s_mov_b32 s55, 20000
L_sp2:
    buffer_load_dword v13, v120, s[20:23], s57 offen sc1
    s_waitcnt vmcnt(0)
    v_cmp_gt_u32 vcc, 32, v13
    s_cmp_eq_u64 vcc, 0
    s_cbranch_scc1 L_sd3
    s_sub_u32 s55, s55, 1
    s_cmp_eq_u32 s55, 0
    s_cbranch_scc1 L_sd3
    s_sleep 1
    s_branch L_sp2
L_sd3:
L_pbk1:
    v_exp_f32 v54, v54
    v_exp_f32 v55, v55
    v_exp_f32 v56, v56
    buffer_load_dwordx4 v[160:163], v117, s[20:23], s88 offen sc1
    s_add_u32 s88, s88, 16384
    v_exp_f32 v57, v57
    s_setprio 0
    v_exp_f32 v58, v58
    v_exp_f32 v59, v59
    v_smfmac_f32_32x32x32_bf16 v[80:95], v[100:103], v[48:55], v10
    buffer_load_dwordx4 v[164:167], v117, s[20:23], s88 offen sc1
    s_add_u32 s88, s88, 16384
    v_exp_f32 v60, v60
    v_exp_f32 v61, v61
    v_exp_f32 v62, v62
    v_exp_f32 v63, v63
    v_exp_f32 v32, v32
    v_exp_f32 v33, v33
    v_smfmac_f32_32x32x32_bf16 v[80:95], v[108:111], v[56:63], v10
    v_exp_f32 v34, v34
    s_waitcnt lgkmcnt(0)
    s_barrier
    s_setprio 3
    v_exp_f32 v35, v35
    v_mfma_f32_32x32x16_bf16 v[48:63], v[96:99], v[6:9], 0
    v_exp_f32 v36, v36
    ds_read_b128 v[108:111], v113 offset:50944
    ds_read_b128 v[96:99], v112 offset:0
    ds_read_b128 v[100:103], v113 offset:0
    v_exp_f32 v37, v37
    s_add_u32 s95, s63, 32768
    buffer_load_dwordx4 v[16:19], v0, s[20:23], s95 offen sc1
    v_exp_f32 v38, v38
    v_exp_f32 v39, v39
    v_exp_f32 v40, v40
    buffer_load_dwordx4 v[168:171], v117, s[20:23], s88 offen sc1
    s_add_u32 s88, s88, 16384
    v_exp_f32 v41, v41
    v_exp_f32 v42, v42
    v_exp_f32 v43, v43
    v_smfmac_f32_32x32x32_bf16 v[64:79], v[104:107], v[32:39], v10
    buffer_load_dwordx4 v[172:175], v117, s[20:23], s88 offen sc1
    v_exp_f32 v44, v44
    v_exp_f32 v45, v45
    v_exp_f32 v46, v46
    v_exp_f32 v47, v47
    v_exp_f32 v48, v48
    v_exp_f32 v49, v49
    s_waitcnt lgkmcnt(0)
    v_smfmac_f32_32x32x32_bf16 v[64:79], v[108:111], v[40:47], v10
    v_exp_f32 v50, v50
    v_exp_f32 v51, v51
    v_mfma_f32_32x32x16_bf16 v[32:47], v[96:99], v[2:5], 0
    v_exp_f32 v52, v52
    v_exp_f32 v53, v53
    s_add_u32 s95, s63, 36864
    buffer_load_dwordx4 v[20:23], v0, s[20:23], s95 offen sc1
    v_exp_f32 v54, v54
    v_exp_f32 v55, v55
    v_exp_f32 v56, v56
    buffer_load_dword v159, v118, s[20:23], s89 offen offset:2048 sc1
    v_exp_f32 v57, v57
    v_exp_f32 v58, v58
    v_exp_f32 v59, v59
    v_smfmac_f32_32x32x32_bf16 v[80:95], v[104:107], v[48:55], v10
    buffer_load_dword v122, v121, s[20:23], s91 offen sc1
    v_exp_f32 v60, v60
    v_exp_f32 v61, v61
    v_exp_f32 v62, v62
    v_exp_f32 v63, v63
    v_exp_f32 v32, v32
    v_exp_f32 v33, v33
    v_smfmac_f32_32x32x32_bf16 v[80:95], v[108:111], v[56:63], v10
    v_exp_f32 v34, v34
    v_exp_f32 v35, v35
    v_mfma_f32_32x32x16_bf16 v[48:63], v[96:99], v[6:9], 0
    v_exp_f32 v36, v36
    ds_read_b128 v[108:111], v113 offset:256
    ds_read_b128 v[96:99], v112 offset:4608
    ds_read_b128 v[104:107], v113 offset:4608
    v_exp_f32 v37, v37
    buffer_load_dwordx4 v[136:139], v0, s[20:23], s90 offen sc1
    v_exp_f32 v38, v38
    v_exp_f32 v39, v39
    v_exp_f32 v40, v40
    v_exp_f32 v41, v41
    v_exp_f32 v42, v42
    v_exp_f32 v43, v43
    v_smfmac_f32_32x32x32_bf16 v[64:79], v[100:103], v[32:39], v10
    v_exp_f32 v44, v44
    v_exp_f32 v45, v45
    v_exp_f32 v46, v46
    v_exp_f32 v47, v47
    v_exp_f32 v48, v48
    v_exp_f32 v49, v49
    s_waitcnt lgkmcnt(0)
    v_smfmac_f32_32x32x32_bf16 v[64:79], v[108:111], v[40:47], v10
    v_exp_f32 v50, v50
    v_exp_f32 v51, v51
    v_mfma_f32_32x32x16_bf16 v[32:47], v[96:99], v[2:5], 0
    v_exp_f32 v52, v52
    v_exp_f32 v53, v53
    buffer_load_dwordx4 v[140:143], v0, s[20:23], s90 offen offset:1024 sc1
    v_exp_f32 v54, v54
    v_exp_f32 v55, v55
    v_exp_f32 v56, v56
    v_exp_f32 v57, v57
    v_exp_f32 v58, v58
    v_exp_f32 v59, v59
    v_smfmac_f32_32x32x32_bf16 v[80:95], v[100:103], v[48:55], v10
    v_exp_f32 v60, v60
    v_exp_f32 v61, v61
    v_exp_f32 v62, v62
    v_exp_f32 v63, v63
    v_exp_f32 v32, v32
    v_exp_f32 v33, v33
    v_smfmac_f32_32x32x32_bf16 v[80:95], v[108:111], v[56:63], v10
    v_exp_f32 v34, v34
    v_exp_f32 v35, v35
    v_mfma_f32_32x32x16_bf16 v[48:63], v[96:99], v[6:9], 0
    v_exp_f32 v36, v36
    ds_read_b128 v[108:111], v113 offset:4864
    ds_read_b128 v[96:99], v112 offset:9216
    ds_read_b128 v[100:103], v113 offset:9216
    v_exp_f32 v37, v37
    s_add_u32 s95, s63, 40960
    buffer_load_dwordx4 v[24:27], v0, s[20:23], s95 offen sc1
    v_exp_f32 v38, v38
    v_exp_f32 v39, v39
    v_exp_f32 v40, v40
    s_add_u32 s50, s98, 524288
    buffer_load_dwordx4 v[192:195], v0, s[20:23], s50 offen offset:0 sc1
    s_setprio 2
    v_exp_f32 v41, v41
    v_exp_f32 v42, v42
    v_exp_f32 v43, v43
    v_smfmac_f32_32x32x32_bf16 v[64:79], v[104:107], v[32:39], v10
    v_exp_f32 v44, v44
    v_exp_f32 v45, v45
    v_exp_f32 v46, v46
    v_exp_f32 v47, v47
    v_exp_f32 v48, v48
    v_exp_f32 v49, v49
    s_waitcnt lgkmcnt(0)
    v_smfmac_f32_32x32x32_bf16 v[64:79], v[108:111], v[40:47], v10
    v_exp_f32 v50, v50
    v_exp_f32 v51, v51
    v_mfma_f32_32x32x16_bf16 v[32:47], v[96:99], v[2:5], 0
    v_exp_f32 v52, v52
    v_exp_f32 v53, v53
    s_waitcnt vmcnt(9)
    ds_write_b128 v114, v[16:19] offset:18432
    s_add_u32 s95, s63, 45056
    buffer_load_dwordx4 v[28:31], v0, s[20:23], s95 offen sc1
    v_exp_f32 v54, v54
    v_exp_f32 v55, v55
    v_exp_f32 v56, v56
    s_waitcnt vmcnt(6)
    v_add_f32_dpp v159, v159, v159 row_ror:8 row_mask:0xf bank_mask:0xf
    v_add_f32 v160, v160, v164
    v_add_f32 v161, v161, v165
    v_add_f32 v162, v162, v166
    v_add_f32 v163, v163, v167
    v_add_f32_dpp v159, v159, v159 row_ror:4 row_mask:0xf bank_mask:0xf
    v_add_f32 v168, v168, v172
    v_add_f32 v169, v169, v173
    v_add_f32 v170, v170, v174
    v_add_f32 v171, v171, v175
    v_add_f32_dpp v159, v159, v159 row_ror:2 row_mask:0xf bank_mask:0xf
    v_exp_f32 v57, v57
    v_exp_f32 v58, v58
    v_exp_f32 v59, v59
    v_smfmac_f32_32x32x32_bf16 v[80:95], v[104:107], v[48:55], v10
    v_add_f32 v160, v160, v168
    v_add_f32 v161, v161, v169
    v_add_f32 v162, v162, v170
    v_add_f32 v163, v163, v171
    v_add_f32_dpp v159, v159, v159 row_ror:1 row_mask:0xf bank_mask:0xf
    buffer_load_dwordx4 v[196:199], v0, s[20:23], s50 offen offset:1024 sc1
    v_exp_f32 v60, v60
    v_exp_f32 v61, v61
    v_exp_f32 v62, v62
    v_exp_f32 v63, v63
    v_exp_f32 v32, v32
    v_exp_f32 v33, v33
    v_smfmac_f32_32x32x32_bf16 v[80:95], v[108:111], v[56:63], v10
    v_exp_f32 v34, v34
    v_exp_f32 v35, v35
    v_mfma_f32_32x32x16_bf16 v[48:63], v[96:99], v[6:9], 0
    v_exp_f32 v36, v36
    ds_read_b128 v[108:111], v113 offset:9472
    ds_read_b128 v[96:99], v112 offset:13824
    ds_read_b128 v[104:107], v113 offset:13824
    v_exp_f32 v37, v37
    s_waitcnt vmcnt(8)
    ds_write_b128 v114, v[20:23] offset:27648
    v_permlane32_swap_b32 v160, v162
    v_permlane32_swap_b32 v161, v163
    v_add_f32 v160, v160, v162
    v_add_f32 v161, v161, v163
    v_exp_f32 v38, v38
    v_exp_f32 v39, v39
    v_exp_f32 v40, v40
    v_permlane16_swap_b32 v160, v161
    v_add_f32 v160, v160, v161
    v_cvt_pk_bf16_f32 v160, v160, v159
    s_setprio 1
    v_exp_f32 v41, v41
    v_exp_f32 v42, v42
    v_exp_f32 v43, v43
    v_smfmac_f32_32x32x32_bf16 v[64:79], v[100:103], v[32:39], v10
    buffer_load_dwordx4 v[200:203], v0, s[20:23], s50 offen offset:2048 sc1
    v_exp_f32 v44, v44
    v_exp_f32 v45, v45
    v_exp_f32 v46, v46
    v_exp_f32 v47, v47
    v_exp_f32 v48, v48
    v_exp_f32 v49, v49
    s_waitcnt lgkmcnt(0)
    v_smfmac_f32_32x32x32_bf16 v[64:79], v[108:111], v[40:47], v10
    v_exp_f32 v50, v50
    v_exp_f32 v51, v51
    v_mfma_f32_32x32x16_bf16 v[32:47], v[96:99], v[2:5], 0
    v_exp_f32 v52, v52
    v_exp_f32 v53, v53
    ds_write_b16 v119, v160
    ds_write_b16_d16_hi v119, v160 offset:1024
    v_exp_f32 v54, v54
    v_exp_f32 v55, v55
    v_exp_f32 v56, v56
    buffer_load_dwordx4 v[204:207], v0, s[20:23], s50 offen offset:3072 sc1
    v_exp_f32 v57, v57
    s_setprio 0
    v_exp_f32 v58, v58
    v_exp_f32 v59, v59
    v_smfmac_f32_32x32x32_bf16 v[80:95], v[100:103], v[48:55], v10
    v_exp_f32 v60, v60
    v_exp_f32 v61, v61
    v_exp_f32 v62, v62
    v_exp_f32 v63, v63
    v_exp_f32 v32, v32
    v_exp_f32 v33, v33
    v_smfmac_f32_32x32x32_bf16 v[80:95], v[108:111], v[56:63], v10
    v_exp_f32 v34, v34
    s_waitcnt lgkmcnt(0)
    s_barrier
    s_setprio 3
    v_exp_f32 v35, v35
    v_mfma_f32_32x32x16_bf16 v[48:63], v[96:99], v[6:9], 0
    v_exp_f32 v36, v36
    ds_read_b128 v[108:111], v113 offset:14080
    ds_read_b128 v[96:99], v112 offset:18432
    ds_read_b128 v[100:103], v113 offset:18432
    v_exp_f32 v37, v37
    ds_read_b128 v[128:131], v116
    ds_read_b128 v[132:135], v116 offset:1024
    v_exp_f32 v38, v38
    v_exp_f32 v39, v39
    v_exp_f32 v40, v40
    s_add_u32 s50, s98, 528384
    buffer_load_dwordx4 v[208:211], v0, s[20:23], s50 offen offset:0 sc1
    v_exp_f32 v41, v41
    v_exp_f32 v42, v42
    v_exp_f32 v43, v43
    v_smfmac_f32_32x32x32_bf16 v[64:79], v[104:107], v[32:39], v10
    v_exp_f32 v44, v44
    v_exp_f32 v45, v45
    v_exp_f32 v46, v46
    v_exp_f32 v47, v47
    v_exp_f32 v48, v48
    v_exp_f32 v49, v49
    s_waitcnt lgkmcnt(0)
    v_smfmac_f32_32x32x32_bf16 v[64:79], v[108:111], v[40:47], v10
    v_exp_f32 v50, v50
    v_exp_f32 v51, v51
    v_mfma_f32_32x32x16_bf16 v[32:47], v[96:99], v[2:5], 0
    v_exp_f32 v52, v52
    v_exp_f32 v53, v53
    buffer_load_dwordx4 v[212:215], v0, s[20:23], s50 offen offset:1024 sc1
    v_exp_f32 v54, v54
    v_exp_f32 v55, v55
    v_exp_f32 v56, v56
    v_exp_f32 v57, v57
    v_exp_f32 v58, v58
    v_exp_f32 v59, v59
    v_smfmac_f32_32x32x32_bf16 v[80:95], v[104:107], v[48:55], v10
    v_exp_f32 v60, v60
    v_exp_f32 v61, v61
    v_exp_f32 v62, v62
    v_exp_f32 v63, v63
    v_exp_f32 v32, v32
    v_exp_f32 v33, v33
    v_smfmac_f32_32x32x32_bf16 v[80:95], v[108:111], v[56:63], v10
    v_exp_f32 v34, v34
    v_exp_f32 v35, v35
    v_mfma_f32_32x32x16_bf16 v[48:63], v[96:99], v[6:9], 0
    v_exp_f32 v36, v36
    ds_read_b128 v[108:111], v113 offset:18688
    ds_read_b128 v[96:99], v112 offset:23040
    ds_read_b128 v[104:107], v113 offset:23040
    v_exp_f32 v37, v37
    s_waitcnt vmcnt(8)
    v_mfma_f32_16x16x32_bf16 v[184:187], v[132:135], v[136:139], 0
    v_mfma_f32_16x16x32_bf16 v[188:191], v[132:135], v[140:143], 0
    v_exp_f32 v38, v38
    v_exp_f32 v39, v39
    v_exp_f32 v40, v40
    v_mfma_f32_16x16x32_bf16 v[176:179], v[128:131], v[136:139], 0
    v_mfma_f32_16x16x32_bf16 v[180:183], v[128:131], v[140:143], 0
    v_exp_f32 v41, v41
    v_exp_f32 v42, v42
    v_exp_f32 v43, v43
    v_smfmac_f32_32x32x32_bf16 v[64:79], v[100:103], v[32:39], v10
    buffer_load_dwordx4 v[216:219], v0, s[20:23], s50 offen offset:2048 sc1
    v_exp_f32 v44, v44
    v_exp_f32 v45, v45
    v_exp_f32 v46, v46
    v_exp_f32 v47, v47
    v_exp_f32 v48, v48
    v_exp_f32 v49, v49
    s_waitcnt lgkmcnt(0)
    v_smfmac_f32_32x32x32_bf16 v[64:79], v[108:111], v[40:47], v10
    v_exp_f32 v50, v50
    v_exp_f32 v51, v51
    v_mfma_f32_32x32x16_bf16 v[32:47], v[96:99], v[2:5], 0
    v_exp_f32 v52, v52
    v_exp_f32 v53, v53
    v_add_f32 v184, 0x358637bd, v184
    v_add_f32 v188, 0x358637bd, v188
    v_rcp_f32 v184, v184
    v_rcp_f32 v188, v188
    v_mul_f32 v176, v176, v184
    v_mul_f32 v177, v177, v184
    v_mul_f32 v178, v178, v184
    v_mul_f32 v179, v179, v184
    v_mul_f32 v180, v180, v188
    v_mul_f32 v181, v181, v188
    v_mul_f32 v182, v182, v188
    v_mul_f32 v183, v183, v188
    v_exp_f32 v54, v54
    v_exp_f32 v55, v55
    v_exp_f32 v56, v56
    v_cvt_pk_bf16_f32 v176, v176, v177
    v_cvt_pk_bf16_f32 v177, v178, v179
    v_cvt_pk_bf16_f32 v178, v180, v181
    v_cvt_pk_bf16_f32 v179, v182, v183
    v_exp_f32 v57, v57
    v_exp_f32 v58, v58
    v_exp_f32 v59, v59
    v_smfmac_f32_32x32x32_bf16 v[80:95], v[100:103], v[48:55], v10
    buffer_load_dwordx4 v[220:223], v0, s[20:23], s50 offen offset:3072 sc1
    v_exp_f32 v60, v60
    v_exp_f32 v61, v61
    v_exp_f32 v62, v62
    v_exp_f32 v63, v63
    v_exp_f32 v32, v32
    v_exp_f32 v33, v33
    v_smfmac_f32_32x32x32_bf16 v[80:95], v[108:111], v[56:63], v10
    v_exp_f32 v34, v34
    v_exp_f32 v35, v35
    v_mfma_f32_32x32x16_bf16 v[48:63], v[96:99], v[6:9], 0
    v_exp_f32 v36, v36
    ds_read_b128 v[108:111], v113 offset:23296
    ds_read_b128 v[96:99], v112 offset:27648
    ds_read_b128 v[100:103], v113 offset:27648
    v_exp_f32 v37, v37
    s_add_u32 s95, s63, 49152
    buffer_load_dwordx4 v[16:19], v0, s[20:23], s95 offen sc1
    v_permlane16_swap_b32 v176, v178
    v_permlane16_swap_b32 v177, v179
    v_exp_f32 v38, v38
    v_exp_f32 v39, v39
    v_exp_f32 v40, v40
    buffer_store_dwordx4 v[176:179], v0, s[20:23], s38 offen sc1
    s_setprio 2
    v_exp_f32 v41, v41
    v_exp_f32 v42, v42
    v_exp_f32 v43, v43
    v_smfmac_f32_32x32x32_bf16 v[64:79], v[104:107], v[32:39], v10
    s_add_u32 s50, s98, 532480
    buffer_load_dwordx4 v[224:227], v0, s[20:23], s50 offen offset:0 sc1
    v_exp_f32 v44, v44
    v_exp_f32 v45, v45
    v_exp_f32 v46, v46
    v_exp_f32 v47, v47
    v_exp_f32 v48, v48
    v_exp_f32 v49, v49
    s_waitcnt lgkmcnt(0)
    v_smfmac_f32_32x32x32_bf16 v[64:79], v[108:111], v[40:47], v10
    v_exp_f32 v50, v50
    v_exp_f32 v51, v51
    v_mfma_f32_32x32x16_bf16 v[32:47], v[96:99], v[2:5], 0
    v_exp_f32 v52, v52
    v_exp_f32 v53, v53
    s_waitcnt vmcnt(12)
    ds_write_b128 v114, v[24:27] offset:36864
    v_exp_f32 v54, v54
    v_exp_f32 v55, v55
    v_exp_f32 v56, v56
    s_add_u32 s95, s63, 53248
    buffer_load_dwordx4 v[20:23], v0, s[20:23], s95 offen sc1
    v_exp_f32 v57, v57
    v_exp_f32 v58, v58
    v_exp_f32 v59, v59
    v_smfmac_f32_32x32x32_bf16 v[80:95], v[104:107], v[48:55], v10
    buffer_load_dwordx4 v[228:231], v0, s[20:23], s50 offen offset:1024 sc1
    v_exp_f32 v60, v60
    v_exp_f32 v61, v61
    v_exp_f32 v62, v62
    v_exp_f32 v63, v63
    v_exp_f32 v32, v32
    v_exp_f32 v33, v33
    v_smfmac_f32_32x32x32_bf16 v[80:95], v[108:111], v[56:63], v10
    v_exp_f32 v34, v34
    v_exp_f32 v35, v35
    v_mfma_f32_32x32x16_bf16 v[48:63], v[96:99], v[6:9], 0
    v_exp_f32 v36, v36
    ds_read_b128 v[108:111], v113 offset:27904
    ds_read_b128 v[96:99], v112 offset:32256
    ds_read_b128 v[104:107], v113 offset:32256
    v_exp_f32 v37, v37
    s_waitcnt vmcnt(12)
    ds_write_b128 v114, v[28:31] offset:46080
    v_exp_f32 v38, v38
    v_exp_f32 v39, v39
    v_exp_f32 v40, v40
    buffer_load_dwordx4 v[232:235], v0, s[20:23], s50 offen offset:2048 sc1
    s_setprio 1
    v_exp_f32 v41, v41
    v_exp_f32 v42, v42
    v_exp_f32 v43, v43
    v_smfmac_f32_32x32x32_bf16 v[64:79], v[100:103], v[32:39], v10
    v_exp_f32 v44, v44
    v_exp_f32 v45, v45
    v_exp_f32 v46, v46
    v_exp_f32 v47, v47
    v_exp_f32 v48, v48
    v_exp_f32 v49, v49
    s_waitcnt lgkmcnt(0)
    v_smfmac_f32_32x32x32_bf16 v[64:79], v[108:111], v[40:47], v10
    v_exp_f32 v50, v50
    v_exp_f32 v51, v51
    v_mfma_f32_32x32x16_bf16 v[32:47], v[96:99], v[2:5], 0
    v_exp_f32 v52, v52
    v_exp_f32 v53, v53
    buffer_load_dwordx4 v[236:239], v0, s[20:23], s50 offen offset:3072 sc1
    v_exp_f32 v54, v54
    v_exp_f32 v55, v55
    v_exp_f32 v56, v56
    v_exp_f32 v57, v57
    s_setprio 0
    v_exp_f32 v58, v58
    v_exp_f32 v59, v59
    v_smfmac_f32_32x32x32_bf16 v[80:95], v[100:103], v[48:55], v10
    v_exp_f32 v60, v60
    v_exp_f32 v61, v61
    v_exp_f32 v62, v62
    v_exp_f32 v63, v63
    v_exp_f32 v32, v32
    v_exp_f32 v33, v33
    v_smfmac_f32_32x32x32_bf16 v[80:95], v[108:111], v[56:63], v10
    v_exp_f32 v34, v34
    s_waitcnt vmcnt(5) lgkmcnt(0)
    s_barrier
    s_cmp_lg_u32 s31, 0
    s_cbranch_scc1 L_w0_4
    s_lshl_b32 s56, s40, 8
    s_add_u32 s56, s56, 17831936
    v_mov_b32 v15, 0
    v_mov_b32 v13, 1
    s_mov_b64 exec, 1
    buffer_atomic_add v13, v15, s[20:23], s56 offen sc1
    s_mov_b64 exec, -1
L_w0_4:
    s_setprio 3
    v_exp_f32 v35, v35
    v_mfma_f32_32x32x16_bf16 v[48:63], v[96:99], v[6:9], 0
    v_exp_f32 v36, v36
    ds_read_b128 v[108:111], v113 offset:32512
    ds_read_b128 v[96:99], v112 offset:36864
    ds_read_b128 v[100:103], v113 offset:36864
    v_exp_f32 v37, v37
    s_add_u32 s50, s98, 536576
    buffer_load_dwordx4 v[240:243], v0, s[20:23], s50 offen offset:0 sc1
    v_exp_f32 v38, v38
    v_exp_f32 v39, v39
    v_exp_f32 v40, v40
    v_exp_f32 v41, v41
    v_exp_f32 v42, v42
    v_exp_f32 v43, v43
    v_smfmac_f32_32x32x32_bf16 v[64:79], v[104:107], v[32:39], v10
    v_exp_f32 v44, v44
    v_exp_f32 v45, v45
    v_exp_f32 v46, v46
    v_exp_f32 v47, v47
    v_exp_f32 v48, v48
    v_exp_f32 v49, v49
    s_waitcnt lgkmcnt(0)
    v_smfmac_f32_32x32x32_bf16 v[64:79], v[108:111], v[40:47], v10
    v_exp_f32 v50, v50
    v_exp_f32 v51, v51
    v_mfma_f32_32x32x16_bf16 v[32:47], v[96:99], v[2:5], 0
    v_exp_f32 v52, v52
    v_exp_f32 v53, v53
    buffer_load_dwordx4 v[244:247], v0, s[20:23], s50 offen offset:1024 sc1
    v_exp_f32 v54, v54
    v_exp_f32 v55, v55
    v_exp_f32 v56, v56
    v_exp_f32 v57, v57
    v_exp_f32 v58, v58
    v_exp_f32 v59, v59
    v_smfmac_f32_32x32x32_bf16 v[80:95], v[104:107], v[48:55], v10
    v_exp_f32 v60, v60
    v_exp_f32 v61, v61
    v_exp_f32 v62, v62
    v_exp_f32 v63, v63
    v_exp_f32 v32, v32
    v_exp_f32 v33, v33
    v_smfmac_f32_32x32x32_bf16 v[80:95], v[108:111], v[56:63], v10
    v_exp_f32 v34, v34
    v_exp_f32 v35, v35
    v_mfma_f32_32x32x16_bf16 v[48:63], v[96:99], v[6:9], 0
    v_exp_f32 v36, v36
    ds_read_b128 v[108:111], v113 offset:37120
    ds_read_b128 v[96:99], v112 offset:41472
    ds_read_b128 v[104:107], v113 offset:41472
    v_exp_f32 v37, v37
    buffer_load_dwordx4 v[248:251], v0, s[20:23], s50 offen offset:2048 sc1
    v_exp_f32 v38, v38
    v_exp_f32 v39, v39
    v_exp_f32 v40, v40
    v_exp_f32 v41, v41
    v_exp_f32 v42, v42
    v_exp_f32 v43, v43
    v_smfmac_f32_32x32x32_bf16 v[64:79], v[100:103], v[32:39], v10
    v_exp_f32 v44, v44
    v_exp_f32 v45, v45
    v_exp_f32 v46, v46
    v_exp_f32 v47, v47
    v_exp_f32 v48, v48
    v_exp_f32 v49, v49
    s_waitcnt lgkmcnt(0)
    v_smfmac_f32_32x32x32_bf16 v[64:79], v[108:111], v[40:47], v10
    v_exp_f32 v50, v50
    v_exp_f32 v51, v51
    v_mfma_f32_32x32x16_bf16 v[32:47], v[96:99], v[2:5], 0
    v_exp_f32 v52, v52
    v_exp_f32 v53, v53
    buffer_load_dwordx4 v[252:255], v0, s[20:23], s50 offen offset:3072 sc1
    v_exp_f32 v54, v54
    v_exp_f32 v55, v55
    v_exp_f32 v56, v56
    v_exp_f32 v57, v57
    v_exp_f32 v58, v58
    v_exp_f32 v59, v59
    v_smfmac_f32_32x32x32_bf16 v[80:95], v[100:103], v[48:55], v10
    v_exp_f32 v60, v60
    v_exp_f32 v61, v61
    v_exp_f32 v62, v62
    v_exp_f32 v63, v63
    v_exp_f32 v32, v32
    v_exp_f32 v33, v33
    v_smfmac_f32_32x32x32_bf16 v[80:95], v[108:111], v[56:63], v10
    v_exp_f32 v34, v34
    v_exp_f32 v35, v35
    v_mfma_f32_32x32x16_bf16 v[48:63], v[96:99], v[6:9], 0
    v_exp_f32 v36, v36
    ds_read_b128 v[108:111], v113 offset:41728
    ds_read_b128 v[96:99], v112 offset:46080
    ds_read_b128 v[100:103], v113 offset:46080
    v_exp_f32 v37, v37
    s_add_u32 s95, s63, 57344
    buffer_load_dwordx4 v[24:27], v0, s[20:23], s95 offen sc1
    v_exp_f32 v38, v38
    v_exp_f32 v39, v39
    v_exp_f32 v40, v40
    s_add_u32 s50, s98, 0
    buffer_load_dwordx4 v[128:131], v0, s[20:23], s50 offen offset:0 sc1
    s_setprio 2
    v_exp_f32 v41, v41
    v_exp_f32 v42, v42
    v_exp_f32 v43, v43
    v_smfmac_f32_32x32x32_bf16 v[64:79], v[104:107], v[32:39], v10
    v_exp_f32 v44, v44
    v_exp_f32 v45, v45
    v_exp_f32 v46, v46
    v_exp_f32 v47, v47
    v_exp_f32 v48, v48
    v_exp_f32 v49, v49
    s_waitcnt lgkmcnt(0)
    v_smfmac_f32_32x32x32_bf16 v[64:79], v[108:111], v[40:47], v10
    v_exp_f32 v50, v50
    v_exp_f32 v51, v51
    v_mfma_f32_32x32x16_bf16 v[32:47], v[96:99], v[2:5], 0
    v_exp_f32 v52, v52
    v_exp_f32 v53, v53
    s_waitcnt vmcnt(12)
    ds_write_b128 v114, v[16:19] offset:0
    v_exp_f32 v54, v54
    v_exp_f32 v55, v55
    v_exp_f32 v56, v56
    s_add_u32 s95, s63, 61440
    buffer_load_dwordx4 v[28:31], v0, s[20:23], s95 offen sc1
    v_exp_f32 v57, v57
    v_exp_f32 v58, v58
    v_exp_f32 v59, v59
    v_smfmac_f32_32x32x32_bf16 v[80:95], v[104:107], v[48:55], v10
    buffer_load_dwordx4 v[132:135], v0, s[20:23], s50 offen offset:1024 sc1
    v_exp_f32 v60, v60
    v_exp_f32 v61, v61
    v_exp_f32 v62, v62
    v_exp_f32 v63, v63
    v_exp_f32 v32, v32
    v_exp_f32 v33, v33
    v_smfmac_f32_32x32x32_bf16 v[80:95], v[108:111], v[56:63], v10
    v_exp_f32 v34, v34
    v_exp_f32 v35, v35
    v_mfma_f32_32x32x16_bf16 v[48:63], v[96:99], v[6:9], 0
    v_exp_f32 v36, v36
    ds_read_b128 v[108:111], v113 offset:46336
    ds_read_b128 v[96:99], v112 offset:50688
    ds_read_b128 v[104:107], v113 offset:50688
    v_exp_f32 v37, v37
    s_waitcnt vmcnt(11)
    ds_write_b128 v114, v[20:23] offset:9216
    v_exp_f32 v38, v38
    v_exp_f32 v39, v39
    v_exp_f32 v40, v40
    buffer_load_dwordx4 v[136:139], v0, s[20:23], s50 offen offset:2048 sc1
    s_setprio 1
    v_exp_f32 v41, v41
    v_exp_f32 v42, v42
    v_exp_f32 v43, v43
    v_smfmac_f32_32x32x32_bf16 v[64:79], v[100:103], v[32:39], v10
    v_exp_f32 v44, v44
    v_exp_f32 v45, v45
    v_exp_f32 v46, v46
    v_exp_f32 v47, v47
    v_exp_f32 v48, v48
    v_exp_f32 v49, v49
    s_waitcnt lgkmcnt(0)
    v_smfmac_f32_32x32x32_bf16 v[64:79], v[108:111], v[40:47], v10
    v_exp_f32 v50, v50
    v_exp_f32 v51, v51
    v_mfma_f32_32x32x16_bf16 v[32:47], v[96:99], v[2:5], 0
    v_exp_f32 v52, v52
    v_exp_f32 v53, v53
    buffer_load_dwordx4 v[140:143], v0, s[20:23], s50 offen offset:3072 sc1
    v_exp_f32 v54, v54
    v_exp_f32 v55, v55
    v_exp_f32 v56, v56
    v_exp_f32 v57, v57
    s_setprio 0
    v_exp_f32 v58, v58
    v_exp_f32 v59, v59
    v_smfmac_f32_32x32x32_bf16 v[80:95], v[100:103], v[48:55], v10
    v_exp_f32 v60, v60
    v_exp_f32 v61, v61
    v_exp_f32 v62, v62
    v_exp_f32 v63, v63
    v_exp_f32 v32, v32
    v_exp_f32 v33, v33
    v_smfmac_f32_32x32x32_bf16 v[80:95], v[108:111], v[56:63], v10
    v_exp_f32 v34, v34
    s_waitcnt lgkmcnt(0)
    s_barrier
    s_setprio 3
    v_exp_f32 v35, v35
    v_mfma_f32_32x32x16_bf16 v[48:63], v[96:99], v[6:9], 0
    v_exp_f32 v36, v36
    ds_read_b128 v[108:111], v113 offset:50944
    ds_read_b128 v[96:99], v112 offset:0
    ds_read_b128 v[100:103], v113 offset:0
    v_exp_f32 v37, v37
    s_add_u32 s50, s98, 4096
    buffer_load_dwordx4 v[144:147], v0, s[20:23], s50 offen offset:0 sc1
    v_exp_f32 v38, v38
    v_exp_f32 v39, v39
    v_exp_f32 v40, v40
    v_exp_f32 v41, v41
    v_exp_f32 v42, v42
    v_exp_f32 v43, v43
    v_smfmac_f32_32x32x32_bf16 v[64:79], v[104:107], v[32:39], v10
    v_exp_f32 v44, v44
    v_exp_f32 v45, v45
    v_exp_f32 v46, v46
    v_exp_f32 v47, v47
    v_exp_f32 v48, v48
    v_exp_f32 v49, v49
    s_waitcnt lgkmcnt(0)
    v_smfmac_f32_32x32x32_bf16 v[64:79], v[108:111], v[40:47], v10
    v_exp_f32 v50, v50
    v_exp_f32 v51, v51
    v_mfma_f32_32x32x16_bf16 v[32:47], v[96:99], v[2:5], 0
    v_exp_f32 v52, v52
    v_exp_f32 v53, v53
    s_lshl_b32 s57, s36, 8
    s_add_u32 s57, s57, 17831936
    v_mov_b32 v120, 0
    buffer_load_dword v176, v120, s[20:23], s57 offen sc1
    s_add_u32 s88, s101, 32768
    v_exp_f32 v54, v54
    v_exp_f32 v55, v55
    v_exp_f32 v56, v56
    v_exp_f32 v57, v57
    v_exp_f32 v58, v58
    v_exp_f32 v59, v59
    v_smfmac_f32_32x32x32_bf16 v[80:95], v[104:107], v[48:55], v10
    v_exp_f32 v60, v60
    v_exp_f32 v61, v61
    v_exp_f32 v62, v62
    v_exp_f32 v63, v63
    v_exp_f32 v32, v32
    v_exp_f32 v33, v33
    v_smfmac_f32_32x32x32_bf16 v[80:95], v[108:111], v[56:63], v10
    v_exp_f32 v34, v34
    v_exp_f32 v35, v35
    v_mfma_f32_32x32x16_bf16 v[48:63], v[96:99], v[6:9], 0
    v_exp_f32 v36, v36
    ds_read_b128 v[108:111], v113 offset:256
    ds_read_b128 v[96:99], v112 offset:4608
    ds_read_b128 v[104:107], v113 offset:4608
    v_exp_f32 v37, v37
    buffer_load_dwordx4 v[148:151], v0, s[20:23], s50 offen offset:1024 sc1
    v_exp_f32 v38, v38
    v_exp_f32 v39, v39
    v_exp_f32 v40, v40
    v_exp_f32 v41, v41
    v_exp_f32 v42, v42
    v_exp_f32 v43, v43
    v_smfmac_f32_32x32x32_bf16 v[64:79], v[100:103], v[32:39], v10
    v_exp_f32 v44, v44
    v_exp_f32 v45, v45
    v_exp_f32 v46, v46
    v_exp_f32 v47, v47
    v_exp_f32 v48, v48
    v_exp_f32 v49, v49
    s_waitcnt lgkmcnt(0)
    v_smfmac_f32_32x32x32_bf16 v[64:79], v[108:111], v[40:47], v10
    v_exp_f32 v50, v50
    v_exp_f32 v51, v51
    v_mfma_f32_32x32x16_bf16 v[32:47], v[96:99], v[2:5], 0
    v_exp_f32 v52, v52
    v_exp_f32 v53, v53
    buffer_load_dwordx4 v[152:155], v0, s[20:23], s50 offen offset:2048 sc1
    v_exp_f32 v54, v54
    v_exp_f32 v55, v55
    v_exp_f32 v56, v56
    v_exp_f32 v57, v57
    v_exp_f32 v58, v58
    v_exp_f32 v59, v59
    v_smfmac_f32_32x32x32_bf16 v[80:95], v[100:103], v[48:55], v10
    v_exp_f32 v60, v60
    v_exp_f32 v61, v61
    v_exp_f32 v62, v62
    v_exp_f32 v63, v63
    v_exp_f32 v32, v32
    v_exp_f32 v33, v33
    v_smfmac_f32_32x32x32_bf16 v[80:95], v[108:111], v[56:63], v10
    v_exp_f32 v34, v34
    v_exp_f32 v35, v35
    v_mfma_f32_32x32x16_bf16 v[48:63], v[96:99], v[6:9], 0
    v_exp_f32 v36, v36
    ds_read_b128 v[108:111], v113 offset:4864
    ds_read_b128 v[96:99], v112 offset:9216
    ds_read_b128 v[100:103], v113 offset:9216
    v_exp_f32 v37, v37
    s_waitcnt vmcnt(2)
    v_cmp_gt_u32 vcc, 32, v176
    s_cmp_eq_u64 vcc, 0
    s_cbranch_scc1 L_pck5
    s_mov_b32 s55, 20000
L_sp6:
    buffer_load_dword v13, v120, s[20:23], s57 offen sc1
    s_waitcnt vmcnt(0)
    v_cmp_gt_u32 vcc, 32, v13
    s_cmp_eq_u64 vcc, 0
    s_cbranch_scc1 L_sd7
    s_sub_u32 s55, s55, 1
    s_cmp_eq_u32 s55, 0
    s_cbranch_scc1 L_sd7
    s_sleep 1
    s_branch L_sp6
L_sd7:
L_pck5:
    buffer_load_dwordx4 v[176:179], v123, s[20:23], s88 offen offset:0 sc1
    v_exp_f32 v38, v38
    v_exp_f32 v39, v39
    v_exp_f32 v40, v40
    buffer_load_dwordx4 v[180:183], v123, s[20:23], s88 offen offset:256 sc1
    s_setprio 2
    v_exp_f32 v41, v41
    v_exp_f32 v42, v42
    v_exp_f32 v43, v43
    v_smfmac_f32_32x32x32_bf16 v[64:79], v[104:107], v[32:39], v10
    buffer_load_dwordx4 v[156:159], v0, s[20:23], s50 offen offset:3072 sc1
    v_exp_f32 v44, v44
    v_exp_f32 v45, v45
    v_exp_f32 v46, v46
    v_exp_f32 v47, v47
    v_exp_f32 v48, v48
    v_exp_f32 v49, v49
    s_waitcnt lgkmcnt(0)
    v_smfmac_f32_32x32x32_bf16 v[64:79], v[108:111], v[40:47], v10
    v_exp_f32 v50, v50
    v_exp_f32 v51, v51
    v_mfma_f32_32x32x16_bf16 v[32:47], v[96:99], v[2:5], 0
    v_exp_f32 v52, v52
    v_exp_f32 v53, v53
    s_waitcnt vmcnt(12)
    ds_write_b128 v114, v[24:27] offset:18432
    buffer_load_dwordx4 v[184:187], v123, s[20:23], s88 offen offset:2048 sc1
    v_exp_f32 v54, v54
    v_exp_f32 v55, v55
    v_exp_f32 v56, v56
    buffer_load_dwordx4 v[188:191], v123, s[20:23], s88 offen offset:2304 sc1
    v_exp_f32 v57, v57
    v_exp_f32 v58, v58
    v_exp_f32 v59, v59
    v_smfmac_f32_32x32x32_bf16 v[80:95], v[104:107], v[48:55], v10
    s_add_u32 s50, s98, 8192
    buffer_load_dwordx4 v[160:163], v0, s[20:23], s50 offen offset:0 sc1
    v_exp_f32 v60, v60
    v_exp_f32 v61, v61
    v_exp_f32 v62, v62
    v_exp_f32 v63, v63
    v_exp_f32 v32, v32
    v_exp_f32 v33, v33
    v_smfmac_f32_32x32x32_bf16 v[80:95], v[108:111], v[56:63], v10
    v_exp_f32 v34, v34
    v_exp_f32 v35, v35
    v_mfma_f32_32x32x16_bf16 v[48:63], v[96:99], v[6:9], 0
    v_exp_f32 v36, v36
    ds_read_b128 v[108:111], v113 offset:9472
    ds_read_b128 v[96:99], v112 offset:13824
    ds_read_b128 v[104:107], v113 offset:13824
    v_exp_f32 v37, v37
    s_waitcnt vmcnt(13)
    ds_write_b128 v114, v[28:31] offset:27648
    v_exp_f32 v38, v38
    v_exp_f32 v39, v39
    v_exp_f32 v40, v40
    v_add_u32 v118, 0x8000, v115
    s_lshl_b32 s91, s100, 9
    s_add_u32 s91, s91, 12582912
    v_and_b32 v121, 0x9c, v121
    s_setprio 1
    v_exp_f32 v41, v41
    v_exp_f32 v42, v42
    v_exp_f32 v43, v43
    v_smfmac_f32_32x32x32_bf16 v[64:79], v[100:103], v[32:39], v10
    buffer_load_dwordx4 v[164:167], v0, s[20:23], s50 offen offset:1024 sc1
    v_exp_f32 v44, v44
    v_exp_f32 v45, v45
    v_exp_f32 v46, v46
    v_exp_f32 v47, v47
    v_exp_f32 v48, v48
    v_exp_f32 v49, v49
    s_waitcnt lgkmcnt(0)
    v_smfmac_f32_32x32x32_bf16 v[64:79], v[108:111], v[40:47], v10
    v_exp_f32 v50, v50
    v_exp_f32 v51, v51
    v_mfma_f32_32x32x16_bf16 v[32:47], v[96:99], v[2:5], 0
    v_exp_f32 v52, v52
    v_exp_f32 v53, v53
    buffer_load_dword v125, v121, s[20:23], s91 offen sc1
    buffer_load_dword v126, v121, s[20:23], s91 offen offset:256 sc1
    v_exp_f32 v54, v54
    v_exp_f32 v55, v55
    v_exp_f32 v56, v56
    v_exp_f32 v57, v57
    s_setprio 0
    v_exp_f32 v58, v58
    v_exp_f32 v59, v59
    v_smfmac_f32_32x32x32_bf16 v[80:95], v[100:103], v[48:55], v10
    v_exp_f32 v60, v60
    v_exp_f32 v61, v61
    v_exp_f32 v62, v62
    v_exp_f32 v63, v63
    v_exp_f32 v32, v32
    v_exp_f32 v33, v33
    v_smfmac_f32_32x32x32_bf16 v[80:95], v[108:111], v[56:63], v10
    v_exp_f32 v34, v34
    s_waitcnt lgkmcnt(0)
    s_barrier
    s_setprio 3
    v_exp_f32 v35, v35
    v_mfma_f32_32x32x16_bf16 v[48:63], v[96:99], v[6:9], 0
    v_exp_f32 v36, v36
    ds_read_b128 v[108:111], v113 offset:14080
    ds_read_b128 v[96:99], v112 offset:18432
    ds_read_b128 v[100:103], v113 offset:18432
    v_exp_f32 v37, v37
    buffer_load_dwordx4 v[168:171], v0, s[20:23], s50 offen offset:2048 sc1
    v_exp_f32 v38, v38
    v_exp_f32 v39, v39
    v_exp_f32 v40, v40
    v_exp_f32 v41, v41
    v_exp_f32 v42, v42
    v_exp_f32 v43, v43
    v_smfmac_f32_32x32x32_bf16 v[64:79], v[104:107], v[32:39], v10
    v_exp_f32 v44, v44
    v_exp_f32 v45, v45
    v_exp_f32 v46, v46
    v_exp_f32 v47, v47
    v_exp_f32 v48, v48
    v_exp_f32 v49, v49
    s_waitcnt lgkmcnt(0)
    v_smfmac_f32_32x32x32_bf16 v[64:79], v[108:111], v[40:47], v10
    v_exp_f32 v50, v50
    v_exp_f32 v51, v51
    v_mfma_f32_32x32x16_bf16 v[32:47], v[96:99], v[2:5], 0
    v_exp_f32 v52, v52
    v_exp_f32 v53, v53
    s_waitcnt vmcnt(9)
    ds_write_b128 v118, v[176:179] offset:32768
    v_exp_f32 v54, v54
    v_exp_f32 v55, v55
    v_exp_f32 v56, v56
    buffer_load_dwordx4 v[172:175], v0, s[20:23], s50 offen offset:3072 sc1
    v_exp_f32 v57, v57
    v_exp_f32 v58, v58
    v_exp_f32 v59, v59
    v_smfmac_f32_32x32x32_bf16 v[80:95], v[104:107], v[48:55], v10
    v_exp_f32 v60, v60
    v_exp_f32 v61, v61
    v_exp_f32 v62, v62
    v_exp_f32 v63, v63
    v_exp_f32 v32, v32
    v_exp_f32 v33, v33
    v_smfmac_f32_32x32x32_bf16 v[80:95], v[108:111], v[56:63], v10
    v_exp_f32 v34, v34
    v_exp_f32 v35, v35
    v_mfma_f32_32x32x16_bf16 v[48:63], v[96:99], v[6:9], 0
    v_exp_f32 v36, v36
    ds_read_b128 v[108:111], v113 offset:18688
    ds_read_b128 v[96:99], v112 offset:23040
    ds_read_b128 v[104:107], v113 offset:23040
    v_exp_f32 v37, v37
    s_waitcnt vmcnt(9)
    ds_write_b128 v118, v[180:183] offset:33792
    v_exp_f32 v38, v38
    v_exp_f32 v39, v39
    v_exp_f32 v40, v40
    s_add_u32 s50, s98, 12288
    buffer_load_dwordx4 v[176:179], v0, s[20:23], s50 offen offset:0 sc1
    v_exp_f32 v41, v41
    v_exp_f32 v42, v42
    v_exp_f32 v43, v43
    v_smfmac_f32_32x32x32_bf16 v[64:79], v[100:103], v[32:39], v10
    v_exp_f32 v44, v44
    v_exp_f32 v45, v45
    v_exp_f32 v46, v46
    v_exp_f32 v47, v47
    v_exp_f32 v48, v48
    v_exp_f32 v49, v49
    s_waitcnt lgkmcnt(0)
    v_smfmac_f32_32x32x32_bf16 v[64:79], v[108:111], v[40:47], v10
    v_exp_f32 v50, v50
    v_exp_f32 v51, v51
    v_mfma_f32_32x32x16_bf16 v[32:47], v[96:99], v[2:5], 0
    v_exp_f32 v52, v52
    v_exp_f32 v53, v53
    s_waitcnt vmcnt(8)
    ds_write_b128 v118, v[184:187] offset:34816
    v_exp_f32 v54, v54
    v_exp_f32 v55, v55
    v_exp_f32 v56, v56
    buffer_load_dwordx4 v[180:183], v0, s[20:23], s50 offen offset:1024 sc1
    v_exp_f32 v57, v57
    v_exp_f32 v58, v58
    v_exp_f32 v59, v59
    v_smfmac_f32_32x32x32_bf16 v[80:95], v[100:103], v[48:55], v10
    v_exp_f32 v60, v60
    v_exp_f32 v61, v61
    v_exp_f32 v62, v62
    v_exp_f32 v63, v63
    v_exp_f32 v32, v32
    v_exp_f32 v33, v33
    v_smfmac_f32_32x32x32_bf16 v[80:95], v[108:111], v[56:63], v10
    v_exp_f32 v34, v34
    v_exp_f32 v35, v35
    v_mfma_f32_32x32x16_bf16 v[48:63], v[96:99], v[6:9], 0
    v_exp_f32 v36, v36
    ds_read_b128 v[108:111], v113 offset:23296
    ds_read_b128 v[96:99], v112 offset:27648
    ds_read_b128 v[100:103], v113 offset:27648
    v_exp_f32 v37, v37
    s_waitcnt vmcnt(8)
    ds_write_b128 v118, v[188:191] offset:35840
    v_exp_f32 v38, v38
    v_exp_f32 v39, v39
    v_exp_f32 v40, v40
    buffer_load_dwordx4 v[184:187], v0, s[20:23], s50 offen offset:2048 sc1
    v_exp_f32 v41, v41
    v_exp_f32 v42, v42
    v_exp_f32 v43, v43
    v_smfmac_f32_32x32x32_bf16 v[64:79], v[104:107], v[32:39], v10
    v_exp_f32 v44, v44
    v_exp_f32 v45, v45
    v_exp_f32 v46, v46
    v_exp_f32 v47, v47
    v_exp_f32 v48, v48
    v_exp_f32 v49, v49
    s_waitcnt lgkmcnt(0)
    v_smfmac_f32_32x32x32_bf16 v[64:79], v[108:111], v[40:47], v10
    v_exp_f32 v50, v50
    v_exp_f32 v51, v51
    v_mfma_f32_32x32x16_bf16 v[32:47], v[96:99], v[2:5], 0
    v_exp_f32 v52, v52
    v_exp_f32 v53, v53
    buffer_load_dwordx4 v[188:191], v0, s[20:23], s50 offen offset:3072 sc1
    v_exp_f32 v54, v54
    v_exp_f32 v55, v55
    v_exp_f32 v56, v56
    s_setprio 2
    v_exp_f32 v57, v57
    v_exp_f32 v58, v58
    v_exp_f32 v59, v59
    v_smfmac_f32_32x32x32_bf16 v[80:95], v[104:107], v[48:55], v10
    v_exp_f32 v60, v60
    v_exp_f32 v61, v61
    v_exp_f32 v62, v62
    v_exp_f32 v63, v63
    v_exp_f32 v32, v32
    v_exp_f32 v33, v33
    v_smfmac_f32_32x32x32_bf16 v[80:95], v[108:111], v[56:63], v10
    v_exp_f32 v34, v34
    v_exp_f32 v35, v35
    v_mfma_f32_32x32x16_bf16 v[48:63], v[96:99], v[6:9], 0
    v_exp_f32 v36, v36
    ds_read_b128 v[108:111], v113 offset:27904
    ds_read_b128 v[96:99], v112 offset:32256
    ds_read_b128 v[104:107], v113 offset:32256
    v_exp_f32 v37, v37
    v_exp_f32 v38, v38
    v_exp_f32 v39, v39
    v_exp_f32 v40, v40
    v_exp_f32 v41, v41
    v_exp_f32 v42, v42
    v_exp_f32 v43, v43
    v_smfmac_f32_32x32x32_bf16 v[64:79], v[100:103], v[32:39], v10
    v_exp_f32 v44, v44
    v_exp_f32 v45, v45
    v_exp_f32 v46, v46
    v_exp_f32 v47, v47
    v_exp_f32 v48, v48
    v_exp_f32 v49, v49
    s_waitcnt lgkmcnt(0)
    v_smfmac_f32_32x32x32_bf16 v[64:79], v[108:111], v[40:47], v10
    v_exp_f32 v50, v50
    v_exp_f32 v51, v51
    v_mfma_f32_32x32x16_bf16 v[32:47], v[96:99], v[2:5], 0
    v_exp_f32 v52, v52
    v_exp_f32 v53, v53
    v_exp_f32 v54, v54
    v_exp_f32 v55, v55
    v_exp_f32 v56, v56
    v_exp_f32 v57, v57
    v_exp_f32 v58, v58
    v_exp_f32 v59, v59
    v_smfmac_f32_32x32x32_bf16 v[80:95], v[100:103], v[48:55], v10
    v_exp_f32 v60, v60
    v_exp_f32 v61, v61
    v_exp_f32 v62, v62
    v_exp_f32 v63, v63
    v_exp_f32 v32, v32
    s_setprio 1
    v_exp_f32 v33, v33
    v_smfmac_f32_32x32x32_bf16 v[80:95], v[108:111], v[56:63], v10
    v_exp_f32 v34, v34
    v_exp_f32 v35, v35
    v_mfma_f32_32x32x16_bf16 v[48:63], v[96:99], v[6:9], 0
    v_exp_f32 v36, v36
    ds_read_b128 v[108:111], v113 offset:32512
    v_exp_f32 v37, v37
    v_exp_f32 v38, v38
    v_exp_f32 v39, v39
    v_exp_f32 v40, v40
    v_exp_f32 v41, v41
    v_exp_f32 v42, v42
    v_exp_f32 v43, v43
    v_smfmac_f32_32x32x32_bf16 v[64:79], v[104:107], v[32:39], v10
    v_exp_f32 v44, v44
    v_exp_f32 v45, v45
    v_exp_f32 v46, v46
    v_exp_f32 v47, v47
    v_exp_f32 v48, v48
    v_exp_f32 v49, v49
    s_waitcnt lgkmcnt(0)
    v_smfmac_f32_32x32x32_bf16 v[64:79], v[108:111], v[40:47], v10
    v_exp_f32 v50, v50
    v_exp_f32 v51, v51
    v_exp_f32 v52, v52
    s_setprio 0
    v_exp_f32 v53, v53
    v_exp_f32 v54, v54
    v_exp_f32 v55, v55
    v_exp_f32 v56, v56
    v_exp_f32 v57, v57
    v_exp_f32 v58, v58
    v_exp_f32 v59, v59
    v_smfmac_f32_32x32x32_bf16 v[80:95], v[104:107], v[48:55], v10
    v_exp_f32 v60, v60
    v_exp_f32 v61, v61
    ds_write_b128 v115, v[64:67] offset:0
    ds_write_b128 v115, v[68:71] offset:1024
    ds_write_b128 v115, v[72:75] offset:2048
    v_exp_f32 v62, v62
    v_exp_f32 v63, v63
    v_xor_b32 v124, 0x4000, v115
    s_mov_b32 s50, 0x3c000000
    v_smfmac_f32_32x32x32_bf16 v[80:95], v[108:111], v[56:63], v10
    s_setprio 0
    s_movk_i32 s51, 0x207
    s_mov_b32 s54, 0x21800000
    s_waitcnt lgkmcnt(0)
    s_barrier
    ds_read_b128 v[64:67], v124 offset:0
    ds_read_b128 v[68:71], v124 offset:1024
    ds_read_b128 v[72:75], v124 offset:2048
    ds_read_b128 v[32:35], v116 offset:32768
    ds_read_b128 v[36:39], v116 offset:33792
    ds_read_b128 v[40:43], v116 offset:34816
    ds_read_b128 v[44:47], v116 offset:35840
    ds_read_b128 v[48:51], v116 offset:36864
    ds_read_b128 v[52:55], v116 offset:37888
    ds_read_b128 v[56:59], v116 offset:38912
    ds_read_b128 v[60:63], v116 offset:39936
    s_waitcnt lgkmcnt(8)
    v_add_f32 v88, v88, v72
    v_add_f32 v80, v80, v64
    v_add_f32 v81, v81, v65
    v_add_f32 v82, v82, v66
    v_add_f32 v83, v83, v67
    v_add_f32 v84, v84, v68
    v_add_f32 v85, v85, v69
    v_add_f32 v86, v86, v70
    v_add_f32 v87, v87, v71
    v_rcp_f32 v12, v88
    v_add_f32 v13, v80, v81
    v_add_f32 v15, v82, v83
    v_subrev_u32 v11, s54, v88
    v_add_f32 v13, v13, v84
    v_add_f32 v15, v15, v85
    v_add_f32 v13, v13, v86
    v_add_f32 v15, v15, v87
    v_cmp_le_u32 vcc, s50, v11
    v_add_f32 v13, v13, v15
    v_cmp_class_f32 s[56:57], v13, s51
    s_or_b64 vcc, vcc, s[56:57]
    s_cbranch_scc1 L_fallback
L_fin:
    v_mul_f32 v12, v12, v122
    v_mul_f32 v80, v80, v12
    v_mul_f32 v81, v81, v12
    v_mul_f32 v82, v82, v12
    v_mul_f32 v83, v83, v12
    v_mul_f32 v84, v84, v12
    v_mul_f32 v85, v85, v12
    v_mul_f32 v86, v86, v12
    v_mul_f32 v87, v87, v12
    v_cvt_pk_bf16_f32 v80, v80, v81
    v_cvt_pk_bf16_f32 v81, v82, v83
    v_cvt_pk_bf16_f32 v82, v84, v85
    v_cvt_pk_bf16_f32 v83, v86, v87
    buffer_store_dwordx4 v[80:83], v0, s[20:23], s97 offen sc1
    s_mov_b32 s51, 0xff81ff81
    s_lshl_b32 s35, s31, 2
    v_mov_b32 v75, s35
    s_mov_b32 s59, 1
    s_mov_b32 s58, 0xff
    s_mov_b32 s55, 20000
    s_waitcnt vmcnt(1)
    s_waitcnt lgkmcnt(0)
    v_mfma_f32_16x16x32_bf16 v[64:67], v[192:195], v[32:35], 0
    ds_read_b128 v[32:35], v116 offset:40960
    v_and_b32 v76, 7, v1
    v_mfma_f32_16x16x32_bf16 v[68:71], v[192:195], v[36:39], 0
    ds_read_b128 v[36:39], v116 offset:41984
    v_lshlrev_b32 v73, 2, v76
    v_mfma_f32_16x16x32_bf16 v[64:67], v[196:199], v[40:43], v[64:67]
    ds_read_b128 v[40:43], v116 offset:43008
    v_and_b32 v76, 31, v1
    v_mfma_f32_16x16x32_bf16 v[68:71], v[196:199], v[44:47], v[68:71]
    ds_read_b128 v[44:47], v116 offset:44032
    s_lshl_b32 s35, s100, 5
    v_mfma_f32_16x16x32_bf16 v[64:67], v[200:203], v[48:51], v[64:67]
    ds_read_b128 v[48:51], v116 offset:45056
    v_add_u32 v76, s35, v76
    v_mfma_f32_16x16x32_bf16 v[68:71], v[200:203], v[52:55], v[68:71]
    ds_read_b128 v[52:55], v116 offset:46080
    v_lshlrev_b32 v76, 10, v76
    v_mfma_f32_16x16x32_bf16 v[64:67], v[204:207], v[56:59], v[64:67]
    ds_read_b128 v[56:59], v116 offset:47104
    v_lshrrev_b32 v77, 5, v1
    v_mfma_f32_16x16x32_bf16 v[68:71], v[204:207], v[60:63], v[68:71]
    ds_read_b128 v[60:63], v116 offset:48128
    v_lshl_add_u32 v74, v77, 4, v76
    s_waitcnt lgkmcnt(7)
    v_mfma_f32_16x16x32_bf16 v[64:67], v[208:211], v[32:35], v[64:67]
    ds_read_b128 v[32:35], v116 offset:49152
    s_lshl_b32 s34, s41, 8
    s_waitcnt lgkmcnt(7)
    v_mfma_f32_16x16x32_bf16 v[68:71], v[208:211], v[36:39], v[68:71]
    ds_read_b128 v[36:39], v116 offset:50176
    s_lshl_b32 s35, s31, 5
    s_waitcnt lgkmcnt(7)
    v_mfma_f32_16x16x32_bf16 v[64:67], v[212:215], v[40:43], v[64:67]
    ds_read_b128 v[40:43], v116 offset:51200
    s_add_u32 s34, s34, s35
    s_waitcnt lgkmcnt(7)
    v_mfma_f32_16x16x32_bf16 v[68:71], v[212:215], v[44:47], v[68:71]
    ds_read_b128 v[44:47], v116 offset:52224
    v_sub_f32 v125, 1.0, v125
    s_waitcnt lgkmcnt(7)
    v_mfma_f32_16x16x32_bf16 v[64:67], v[216:219], v[48:51], v[64:67]
    ds_read_b128 v[48:51], v116 offset:53248
    v_sub_f32 v126, 1.0, v126
    s_waitcnt lgkmcnt(7)
    v_mfma_f32_16x16x32_bf16 v[68:71], v[216:219], v[52:55], v[68:71]
    ds_read_b128 v[52:55], v116 offset:54272
    s_waitcnt lgkmcnt(7)
    v_mfma_f32_16x16x32_bf16 v[64:67], v[220:223], v[56:59], v[64:67]
    ds_read_b128 v[56:59], v116 offset:55296
    s_waitcnt lgkmcnt(7)
    v_mfma_f32_16x16x32_bf16 v[68:71], v[220:223], v[60:63], v[68:71]
    ds_read_b128 v[60:63], v116 offset:56320
    s_waitcnt lgkmcnt(7)
    v_mfma_f32_16x16x32_bf16 v[64:67], v[224:227], v[32:35], v[64:67]
    ds_read_b128 v[32:35], v116 offset:57344
    s_waitcnt lgkmcnt(7)
    v_mfma_f32_16x16x32_bf16 v[68:71], v[224:227], v[36:39], v[68:71]
    ds_read_b128 v[36:39], v116 offset:58368
    s_waitcnt lgkmcnt(7)
    v_mfma_f32_16x16x32_bf16 v[64:67], v[228:231], v[40:43], v[64:67]
    ds_read_b128 v[40:43], v116 offset:59392
    s_waitcnt lgkmcnt(7)
    v_mfma_f32_16x16x32_bf16 v[68:71], v[228:231], v[44:47], v[68:71]
    ds_read_b128 v[44:47], v116 offset:60416
    s_waitcnt lgkmcnt(7)
    v_mfma_f32_16x16x32_bf16 v[64:67], v[232:235], v[48:51], v[64:67]
    ds_read_b128 v[48:51], v116 offset:61440
    buffer_load_dwordx4 v[16:19], v123, s[20:23], s101 offen offset:0 sc1
    buffer_load_dwordx4 v[20:23], v123, s[20:23], s101 offen offset:256 sc1
    buffer_load_dwordx4 v[24:27], v123, s[20:23], s101 offen offset:2048 sc1
    buffer_load_dwordx4 v[28:31], v123, s[20:23], s101 offen offset:2304 sc1
    s_waitcnt lgkmcnt(7)
    v_mfma_f32_16x16x32_bf16 v[68:71], v[232:235], v[52:55], v[68:71]
    ds_read_b128 v[52:55], v116 offset:62464
    s_waitcnt lgkmcnt(7)
    v_mfma_f32_16x16x32_bf16 v[64:67], v[236:239], v[56:59], v[64:67]
    ds_read_b128 v[56:59], v116 offset:63488
    s_waitcnt lgkmcnt(7)
    v_mfma_f32_16x16x32_bf16 v[68:71], v[236:239], v[60:63], v[68:71]
    ds_read_b128 v[60:63], v116 offset:64512
    s_waitcnt lgkmcnt(7)
    v_mfma_f32_16x16x32_bf16 v[64:67], v[240:243], v[32:35], v[64:67]
    s_waitcnt lgkmcnt(6)
    v_mfma_f32_16x16x32_bf16 v[68:71], v[240:243], v[36:39], v[68:71]
    s_waitcnt lgkmcnt(5)
    v_mfma_f32_16x16x32_bf16 v[64:67], v[244:247], v[40:43], v[64:67]
    s_waitcnt lgkmcnt(4)
    v_mfma_f32_16x16x32_bf16 v[68:71], v[244:247], v[44:47], v[68:71]
    s_waitcnt lgkmcnt(3)
    v_mfma_f32_16x16x32_bf16 v[64:67], v[248:251], v[48:51], v[64:67]
    s_waitcnt lgkmcnt(2)
    v_mfma_f32_16x16x32_bf16 v[68:71], v[248:251], v[52:55], v[68:71]
    ds_read_b32 v72, v73 offset:63488
    s_waitcnt lgkmcnt(2)
    v_mfma_f32_16x16x32_bf16 v[64:67], v[252:255], v[56:59], v[64:67]
    s_waitcnt lgkmcnt(1)
    v_mfma_f32_16x16x32_bf16 v[68:71], v[252:255], v[60:63], v[68:71]
    s_nop 5
    v_mul_f32 v64, v64, v125
    v_mul_f32 v65, v65, v125
    v_mul_f32 v66, v66, v125
    v_mul_f32 v67, v67, v125
    v_mul_f32 v68, v68, v126
    v_mul_f32 v69, v69, v126
    v_mul_f32 v70, v70, v126
    v_mul_f32 v71, v71, v126
    s_branch L_tl1
L_tl:
    ds_read_b32 v72, v73 offset:63488
L_tl1:
    s_waitcnt lgkmcnt(0)
    v_cmp_ne_u32 vcc, 0, v72
    s_and_b32 s57, vcc_lo, s58
    s_cbranch_scc0 L_none
    s_andn2_b32 s58, s58, s57
    s_and_b32 s56, s57, 0xf
    s_cbranch_scc0 L_th52
    s_bitcmp1_b32 s57, 0
    s_cbranch_scc0 L_tg53
    ds_read_b128 v[192:195], v116 offset:0
    ds_read_b128 v[196:199], v116 offset:1024
    ds_read_b128 v[200:203], v116 offset:2048
    ds_read_b128 v[204:207], v116 offset:3072
    s_waitcnt lgkmcnt(3)
    v_mfma_f32_16x16x32_bf16 v[64:67], v[128:131], v[192:195], v[64:67]
    s_waitcnt lgkmcnt(2)
    v_mfma_f32_16x16x32_bf16 v[68:71], v[128:131], v[196:199], v[68:71]
    s_waitcnt lgkmcnt(1)
    v_mfma_f32_16x16x32_bf16 v[64:67], v[132:135], v[200:203], v[64:67]
    s_waitcnt lgkmcnt(0)
    v_mfma_f32_16x16x32_bf16 v[68:71], v[132:135], v[204:207], v[68:71]
L_tg53:
    s_bitcmp1_b32 s57, 1
    s_cbranch_scc0 L_tg54
    ds_read_b128 v[208:211], v116 offset:4096
    ds_read_b128 v[212:215], v116 offset:5120
    ds_read_b128 v[216:219], v116 offset:6144
    ds_read_b128 v[220:223], v116 offset:7168
    s_waitcnt lgkmcnt(3)
    v_mfma_f32_16x16x32_bf16 v[64:67], v[136:139], v[208:211], v[64:67]
    s_waitcnt lgkmcnt(2)
    v_mfma_f32_16x16x32_bf16 v[68:71], v[136:139], v[212:215], v[68:71]
    s_waitcnt lgkmcnt(1)
    v_mfma_f32_16x16x32_bf16 v[64:67], v[140:143], v[216:219], v[64:67]
    s_waitcnt lgkmcnt(0)
    v_mfma_f32_16x16x32_bf16 v[68:71], v[140:143], v[220:223], v[68:71]
L_tg54:
    s_bitcmp1_b32 s57, 2
    s_cbranch_scc0 L_tg55
    ds_read_b128 v[224:227], v116 offset:8192
    ds_read_b128 v[228:231], v116 offset:9216
    ds_read_b128 v[232:235], v116 offset:10240
    ds_read_b128 v[236:239], v116 offset:11264
    s_waitcnt lgkmcnt(3)
    v_mfma_f32_16x16x32_bf16 v[64:67], v[144:147], v[224:227], v[64:67]
    s_waitcnt lgkmcnt(2)
    v_mfma_f32_16x16x32_bf16 v[68:71], v[144:147], v[228:231], v[68:71]
    s_waitcnt lgkmcnt(1)
    v_mfma_f32_16x16x32_bf16 v[64:67], v[148:151], v[232:235], v[64:67]
    s_waitcnt lgkmcnt(0)
    v_mfma_f32_16x16x32_bf16 v[68:71], v[148:151], v[236:239], v[68:71]
L_tg55:
    s_bitcmp1_b32 s57, 3
    s_cbranch_scc0 L_tg56
    ds_read_b128 v[240:243], v116 offset:12288
    ds_read_b128 v[244:247], v116 offset:13312
    ds_read_b128 v[248:251], v116 offset:14336
    ds_read_b128 v[252:255], v116 offset:15360
    s_waitcnt lgkmcnt(3)
    v_mfma_f32_16x16x32_bf16 v[64:67], v[152:155], v[240:243], v[64:67]
    s_waitcnt lgkmcnt(2)
    v_mfma_f32_16x16x32_bf16 v[68:71], v[152:155], v[244:247], v[68:71]
    s_waitcnt lgkmcnt(1)
    v_mfma_f32_16x16x32_bf16 v[64:67], v[156:159], v[248:251], v[64:67]
    s_waitcnt lgkmcnt(0)
    v_mfma_f32_16x16x32_bf16 v[68:71], v[156:159], v[252:255], v[68:71]
L_tg56:
L_th52:
    s_and_b32 s56, s57, 0xf0
    s_cbranch_scc0 L_th57
    s_bitcmp1_b32 s57, 4
    s_cbranch_scc0 L_tg58
    ds_read_b128 v[32:35], v116 offset:16384
    ds_read_b128 v[36:39], v116 offset:17408
    ds_read_b128 v[40:43], v116 offset:18432
    ds_read_b128 v[44:47], v116 offset:19456
    s_waitcnt lgkmcnt(3)
    v_mfma_f32_16x16x32_bf16 v[64:67], v[160:163], v[32:35], v[64:67]
    s_waitcnt lgkmcnt(2)
    v_mfma_f32_16x16x32_bf16 v[68:71], v[160:163], v[36:39], v[68:71]
    s_waitcnt lgkmcnt(1)
    v_mfma_f32_16x16x32_bf16 v[64:67], v[164:167], v[40:43], v[64:67]
    s_waitcnt lgkmcnt(0)
    v_mfma_f32_16x16x32_bf16 v[68:71], v[164:167], v[44:47], v[68:71]
L_tg58:
    s_bitcmp1_b32 s57, 5
    s_cbranch_scc0 L_tg59
    ds_read_b128 v[48:51], v116 offset:20480
    ds_read_b128 v[52:55], v116 offset:21504
    ds_read_b128 v[56:59], v116 offset:22528
    ds_read_b128 v[60:63], v116 offset:23552
    s_waitcnt lgkmcnt(3)
    v_mfma_f32_16x16x32_bf16 v[64:67], v[168:171], v[48:51], v[64:67]
    s_waitcnt lgkmcnt(2)
    v_mfma_f32_16x16x32_bf16 v[68:71], v[168:171], v[52:55], v[68:71]
    s_waitcnt lgkmcnt(1)
    v_mfma_f32_16x16x32_bf16 v[64:67], v[172:175], v[56:59], v[64:67]
    s_waitcnt lgkmcnt(0)
    v_mfma_f32_16x16x32_bf16 v[68:71], v[172:175], v[60:63], v[68:71]
L_tg59:
    s_bitcmp1_b32 s57, 6
    s_cbranch_scc0 L_tg60
    ds_read_b128 v[80:83], v116 offset:24576
    ds_read_b128 v[84:87], v116 offset:25600
    ds_read_b128 v[88:91], v116 offset:26624
    ds_read_b128 v[92:95], v116 offset:27648
    s_waitcnt lgkmcnt(3)
    v_mfma_f32_16x16x32_bf16 v[64:67], v[176:179], v[80:83], v[64:67]
    s_waitcnt lgkmcnt(2)
    v_mfma_f32_16x16x32_bf16 v[68:71], v[176:179], v[84:87], v[68:71]
    s_waitcnt lgkmcnt(1)
    v_mfma_f32_16x16x32_bf16 v[64:67], v[180:183], v[88:91], v[64:67]
    s_waitcnt lgkmcnt(0)
    v_mfma_f32_16x16x32_bf16 v[68:71], v[180:183], v[92:95], v[68:71]
L_tg60:
    s_bitcmp1_b32 s57, 7
    s_cbranch_scc0 L_tg61
    ds_read_b128 v[96:99], v116 offset:28672
    ds_read_b128 v[100:103], v116 offset:29696
    ds_read_b128 v[104:107], v116 offset:30720
    ds_read_b128 v[108:111], v116 offset:31744
    s_waitcnt lgkmcnt(3)
    v_mfma_f32_16x16x32_bf16 v[64:67], v[184:187], v[96:99], v[64:67]
    s_waitcnt lgkmcnt(2)
    v_mfma_f32_16x16x32_bf16 v[68:71], v[184:187], v[100:103], v[68:71]
    s_waitcnt lgkmcnt(1)
    v_mfma_f32_16x16x32_bf16 v[64:67], v[188:191], v[104:107], v[64:67]
    s_waitcnt lgkmcnt(0)
    v_mfma_f32_16x16x32_bf16 v[68:71], v[188:191], v[108:111], v[68:71]
L_tg61:
L_th57:
    s_cmp_eq_u32 s58, 0
    s_cbranch_scc1 L_done
L_none:
    s_sub_u32 s55, s55, 1
    s_cmp_eq_u32 s55, 0
    s_cbranch_scc1 L_done
    s_cmp_eq_u32 s59, 0
    s_cbranch_scc1 L_w
    s_waitcnt vmcnt(0)
    v_max_u32 v13, v17, v19
    v_max_u32 v15, v21, v23
    v_max_u32 v11, v25, v27
    v_max_u32 v12, v29, v31
    v_cmp_eq_u32 s[88:89], s51, v13
    v_cmp_eq_u32 s[90:91], s51, v15
    v_cmp_eq_u32 s[92:93], s51, v11
    v_cmp_eq_u32 s[94:95], s51, v12
    s_or_b64 s[52:53], s[88:89], s[90:91]
    s_or_b64 vcc, s[92:93], s[94:95]
    s_or_b64 vcc, vcc, s[52:53]
    s_cbranch_scc1 L_r
    ds_write_b128 v118, v[16:19] offset:0
    ds_write_b128 v118, v[20:23] offset:1024
    ds_write_b128 v118, v[24:27] offset:2048
    ds_write_b128 v118, v[28:31] offset:3072
    ds_write_b32 v75, v10 offset:63488
    s_mov_b32 s59, 0
    s_branch L_tl
L_r:
    s_mov_b64 exec, s[88:89]
    buffer_load_dwordx4 v[16:19], v123, s[20:23], s101 offen offset:0 sc1
    s_mov_b64 exec, s[90:91]
    buffer_load_dwordx4 v[20:23], v123, s[20:23], s101 offen offset:256 sc1
    s_mov_b64 exec, s[92:93]
    buffer_load_dwordx4 v[24:27], v123, s[20:23], s101 offen offset:2048 sc1
    s_mov_b64 exec, s[94:95]
    buffer_load_dwordx4 v[28:31], v123, s[20:23], s101 offen offset:2304 sc1
    s_mov_b64 exec, -1
    s_branch L_tl
L_w:
    s_bcnt1_i32_b32 s56, s58
    s_cmp_gt_u32 s56, 2
    s_cbranch_scc1 L_tl
L_w1:
    s_ff1_i32_b32 s56, s58
    s_bitcmp1_b32 s56, 2
    s_cbranch_scc1 L_wt62
    s_bitcmp1_b32 s56, 1
    s_cbranch_scc1 L_wt63
    s_bitcmp1_b32 s56, 0
    s_cbranch_scc1 L_wt64
L_wl65:
    ds_read_b32 v72, v73 offset:63488
    ds_read_b128 v[192:195], v116 offset:0
    ds_read_b128 v[196:199], v116 offset:1024
    ds_read_b128 v[200:203], v116 offset:2048
    ds_read_b128 v[204:207], v116 offset:3072
    s_sub_u32 s55, s55, 1
    s_cbranch_scc1 L_done
    s_waitcnt lgkmcnt(4)
    v_cmp_ne_u32 vcc, 0, v72
    s_bitcmp1_b32 vcc_lo, 0
    s_cbranch_scc0 L_wl65
    s_bitset0_b32 s58, 0
    s_waitcnt lgkmcnt(3)
    v_mfma_f32_16x16x32_bf16 v[64:67], v[128:131], v[192:195], v[64:67]
    s_waitcnt lgkmcnt(2)
    v_mfma_f32_16x16x32_bf16 v[68:71], v[128:131], v[196:199], v[68:71]
    s_waitcnt lgkmcnt(1)
    v_mfma_f32_16x16x32_bf16 v[64:67], v[132:135], v[200:203], v[64:67]
    s_waitcnt lgkmcnt(0)
    v_mfma_f32_16x16x32_bf16 v[68:71], v[132:135], v[204:207], v[68:71]
    s_cmp_eq_u32 s58, 0
    s_cbranch_scc0 L_w1
    s_branch L_done
L_wt64:
L_wl66:
    ds_read_b32 v72, v73 offset:63488
    ds_read_b128 v[208:211], v116 offset:4096
    ds_read_b128 v[212:215], v116 offset:5120
    ds_read_b128 v[216:219], v116 offset:6144
    ds_read_b128 v[220:223], v116 offset:7168
    s_sub_u32 s55, s55, 1
    s_cbranch_scc1 L_done
    s_waitcnt lgkmcnt(4)
    v_cmp_ne_u32 vcc, 0, v72
    s_bitcmp1_b32 vcc_lo, 1
    s_cbranch_scc0 L_wl66
    s_bitset0_b32 s58, 1
    s_waitcnt lgkmcnt(3)
    v_mfma_f32_16x16x32_bf16 v[64:67], v[136:139], v[208:211], v[64:67]
    s_waitcnt lgkmcnt(2)
    v_mfma_f32_16x16x32_bf16 v[68:71], v[136:139], v[212:215], v[68:71]
    s_waitcnt lgkmcnt(1)
    v_mfma_f32_16x16x32_bf16 v[64:67], v[140:143], v[216:219], v[64:67]
    s_waitcnt lgkmcnt(0)
    v_mfma_f32_16x16x32_bf16 v[68:71], v[140:143], v[220:223], v[68:71]
    s_cmp_eq_u32 s58, 0
    s_cbranch_scc0 L_w1
    s_branch L_done
L_wt63:
    s_bitcmp1_b32 s56, 0
    s_cbranch_scc1 L_wt67
L_wl68:
    ds_read_b32 v72, v73 offset:63488
    ds_read_b128 v[224:227], v116 offset:8192
    ds_read_b128 v[228:231], v116 offset:9216
    ds_read_b128 v[232:235], v116 offset:10240
    ds_read_b128 v[236:239], v116 offset:11264
    s_sub_u32 s55, s55, 1
    s_cbranch_scc1 L_done
    s_waitcnt lgkmcnt(4)
    v_cmp_ne_u32 vcc, 0, v72
    s_bitcmp1_b32 vcc_lo, 2
    s_cbranch_scc0 L_wl68
    s_bitset0_b32 s58, 2
    s_waitcnt lgkmcnt(3)
    v_mfma_f32_16x16x32_bf16 v[64:67], v[144:147], v[224:227], v[64:67]
    s_waitcnt lgkmcnt(2)
    v_mfma_f32_16x16x32_bf16 v[68:71], v[144:147], v[228:231], v[68:71]
    s_waitcnt lgkmcnt(1)
    v_mfma_f32_16x16x32_bf16 v[64:67], v[148:151], v[232:235], v[64:67]
    s_waitcnt lgkmcnt(0)
    v_mfma_f32_16x16x32_bf16 v[68:71], v[148:151], v[236:239], v[68:71]
    s_cmp_eq_u32 s58, 0
    s_cbranch_scc0 L_w1
    s_branch L_done
L_wt67:
L_wl69:
    ds_read_b32 v72, v73 offset:63488
    ds_read_b128 v[240:243], v116 offset:12288
    ds_read_b128 v[244:247], v116 offset:13312
    ds_read_b128 v[248:251], v116 offset:14336
    ds_read_b128 v[252:255], v116 offset:15360
    s_sub_u32 s55, s55, 1
    s_cbranch_scc1 L_done
    s_waitcnt lgkmcnt(4)
    v_cmp_ne_u32 vcc, 0, v72
    s_bitcmp1_b32 vcc_lo, 3
    s_cbranch_scc0 L_wl69
    s_bitset0_b32 s58, 3
    s_waitcnt lgkmcnt(3)
    v_mfma_f32_16x16x32_bf16 v[64:67], v[152:155], v[240:243], v[64:67]
    s_waitcnt lgkmcnt(2)
    v_mfma_f32_16x16x32_bf16 v[68:71], v[152:155], v[244:247], v[68:71]
    s_waitcnt lgkmcnt(1)
    v_mfma_f32_16x16x32_bf16 v[64:67], v[156:159], v[248:251], v[64:67]
    s_waitcnt lgkmcnt(0)
    v_mfma_f32_16x16x32_bf16 v[68:71], v[156:159], v[252:255], v[68:71]
    s_cmp_eq_u32 s58, 0
    s_cbranch_scc0 L_w1
    s_branch L_done
L_wt62:
    s_bitcmp1_b32 s56, 1
    s_cbranch_scc1 L_wt70
    s_bitcmp1_b32 s56, 0
    s_cbranch_scc1 L_wt71
L_wl72:
    ds_read_b32 v72, v73 offset:63488
    ds_read_b128 v[32:35], v116 offset:16384
    ds_read_b128 v[36:39], v116 offset:17408
    ds_read_b128 v[40:43], v116 offset:18432
    ds_read_b128 v[44:47], v116 offset:19456
    s_sub_u32 s55, s55, 1
    s_cbranch_scc1 L_done
    s_waitcnt lgkmcnt(4)
    v_cmp_ne_u32 vcc, 0, v72
    s_bitcmp1_b32 vcc_lo, 4
    s_cbranch_scc0 L_wl72
    s_bitset0_b32 s58, 4
    s_waitcnt lgkmcnt(3)
    v_mfma_f32_16x16x32_bf16 v[64:67], v[160:163], v[32:35], v[64:67]
    s_waitcnt lgkmcnt(2)
    v_mfma_f32_16x16x32_bf16 v[68:71], v[160:163], v[36:39], v[68:71]
    s_waitcnt lgkmcnt(1)
    v_mfma_f32_16x16x32_bf16 v[64:67], v[164:167], v[40:43], v[64:67]
    s_waitcnt lgkmcnt(0)
    v_mfma_f32_16x16x32_bf16 v[68:71], v[164:167], v[44:47], v[68:71]
    s_cmp_eq_u32 s58, 0
    s_cbranch_scc0 L_w1
    s_branch L_done
L_wt71:
L_wl73:
    ds_read_b32 v72, v73 offset:63488
    ds_read_b128 v[48:51], v116 offset:20480
    ds_read_b128 v[52:55], v116 offset:21504
    ds_read_b128 v[56:59], v116 offset:22528
    ds_read_b128 v[60:63], v116 offset:23552
    s_sub_u32 s55, s55, 1
    s_cbranch_scc1 L_done
    s_waitcnt lgkmcnt(4)
    v_cmp_ne_u32 vcc, 0, v72
    s_bitcmp1_b32 vcc_lo, 5
    s_cbranch_scc0 L_wl73
    s_bitset0_b32 s58, 5
    s_waitcnt lgkmcnt(3)
    v_mfma_f32_16x16x32_bf16 v[64:67], v[168:171], v[48:51], v[64:67]
    s_waitcnt lgkmcnt(2)
    v_mfma_f32_16x16x32_bf16 v[68:71], v[168:171], v[52:55], v[68:71]
    s_waitcnt lgkmcnt(1)
    v_mfma_f32_16x16x32_bf16 v[64:67], v[172:175], v[56:59], v[64:67]
    s_waitcnt lgkmcnt(0)
    v_mfma_f32_16x16x32_bf16 v[68:71], v[172:175], v[60:63], v[68:71]
    s_cmp_eq_u32 s58, 0
    s_cbranch_scc0 L_w1
    s_branch L_done
L_wt70:
    s_bitcmp1_b32 s56, 0
    s_cbranch_scc1 L_wt74
L_wl75:
    ds_read_b32 v72, v73 offset:63488
    ds_read_b128 v[80:83], v116 offset:24576
    ds_read_b128 v[84:87], v116 offset:25600
    ds_read_b128 v[88:91], v116 offset:26624
    ds_read_b128 v[92:95], v116 offset:27648
    s_sub_u32 s55, s55, 1
    s_cbranch_scc1 L_done
    s_waitcnt lgkmcnt(4)
    v_cmp_ne_u32 vcc, 0, v72
    s_bitcmp1_b32 vcc_lo, 6
    s_cbranch_scc0 L_wl75
    s_bitset0_b32 s58, 6
    s_waitcnt lgkmcnt(3)
    v_mfma_f32_16x16x32_bf16 v[64:67], v[176:179], v[80:83], v[64:67]
    s_waitcnt lgkmcnt(2)
    v_mfma_f32_16x16x32_bf16 v[68:71], v[176:179], v[84:87], v[68:71]
    s_waitcnt lgkmcnt(1)
    v_mfma_f32_16x16x32_bf16 v[64:67], v[180:183], v[88:91], v[64:67]
    s_waitcnt lgkmcnt(0)
    v_mfma_f32_16x16x32_bf16 v[68:71], v[180:183], v[92:95], v[68:71]
    s_cmp_eq_u32 s58, 0
    s_cbranch_scc0 L_w1
    s_branch L_done
L_wt74:
L_wl76:
    ds_read_b32 v72, v73 offset:63488
    ds_read_b128 v[96:99], v116 offset:28672
    ds_read_b128 v[100:103], v116 offset:29696
    ds_read_b128 v[104:107], v116 offset:30720
    ds_read_b128 v[108:111], v116 offset:31744
    s_sub_u32 s55, s55, 1
    s_cbranch_scc1 L_done
    s_waitcnt lgkmcnt(4)
    v_cmp_ne_u32 vcc, 0, v72
    s_bitcmp1_b32 vcc_lo, 7
    s_cbranch_scc0 L_wl76
    s_bitset0_b32 s58, 7
    s_waitcnt lgkmcnt(3)
    v_mfma_f32_16x16x32_bf16 v[64:67], v[184:187], v[96:99], v[64:67]
    s_waitcnt lgkmcnt(2)
    v_mfma_f32_16x16x32_bf16 v[68:71], v[184:187], v[100:103], v[68:71]
    s_waitcnt lgkmcnt(1)
    v_mfma_f32_16x16x32_bf16 v[64:67], v[188:191], v[104:107], v[64:67]
    s_waitcnt lgkmcnt(0)
    v_mfma_f32_16x16x32_bf16 v[68:71], v[188:191], v[108:111], v[68:71]
    s_cmp_eq_u32 s58, 0
    s_cbranch_scc0 L_w1
L_done:
    s_nop 3
    v_cvt_pk_bf16_f32 v64, v64, v65
    v_cvt_pk_bf16_f32 v65, v66, v67
    v_cvt_pk_bf16_f32 v66, v68, v69
    v_cvt_pk_bf16_f32 v67, v70, v71
    s_nop 0
    v_permlane16_swap_b32 v64, v66
    v_permlane16_swap_b32 v65, v67
    buffer_store_dwordx4 v[64:67], v74, s[24:27], s34 offen
L_end:
    s_endpgm
L_phs9:
    s_nop 1
    v_max3_f32 v13, v192, v193, v194
    v_max_f32 v13, v13, v195
    v_mov_b32 v146, v13
    v_mov_b32 v147, v13
    s_nop 1
    v_permlane32_swap_b32 v146, v147
    v_max_f32 v13, v146, v147
    v_mov_b32 v146, v13
    v_mov_b32 v147, v13
    s_nop 1
    v_permlane16_swap_b32 v146, v147
    v_max_f32 v13, v146, v147
    v_min3_f32 v15, v192, v193, v194
    v_min_f32 v15, v15, v195
    v_mov_b32 v146, v15
    v_mov_b32 v147, v15
    s_nop 1
    v_permlane32_swap_b32 v146, v147
    v_min_f32 v15, v146, v147
    v_mov_b32 v146, v15
    v_mov_b32 v147, v15
    s_nop 1
    v_permlane16_swap_b32 v146, v147
    v_min_f32 v15, v146, v147
    v_sub_f32 v160, v192, v13
    v_sub_f32 v164, v15, v192
    v_sub_f32 v161, v193, v13
    v_sub_f32 v165, v15, v193
    v_sub_f32 v162, v194, v13
    v_sub_f32 v166, v15, v194
    v_sub_f32 v163, v195, v13
    v_sub_f32 v167, v15, v195
    v_exp_f32 v160, v160
    v_exp_f32 v161, v161
    v_exp_f32 v162, v162
    v_exp_f32 v163, v163
    v_exp_f32 v164, v164
    v_exp_f32 v165, v165
    v_exp_f32 v166, v166
    v_exp_f32 v167, v167
    v_max3_f32 v13, v196, v197, v198
    v_max_f32 v13, v13, v199
    v_mov_b32 v146, v13
    v_mov_b32 v147, v13
    s_nop 1
    v_permlane32_swap_b32 v146, v147
    v_max_f32 v13, v146, v147
    v_mov_b32 v146, v13
    v_mov_b32 v147, v13
    s_nop 1
    v_permlane16_swap_b32 v146, v147
    v_max_f32 v13, v146, v147
    v_min3_f32 v15, v196, v197, v198
    v_min_f32 v15, v15, v199
    v_mov_b32 v146, v15
    v_mov_b32 v147, v15
    s_nop 1
    v_permlane32_swap_b32 v146, v147
    v_min_f32 v15, v146, v147
    v_mov_b32 v146, v15
    v_mov_b32 v147, v15
    s_nop 1
    v_permlane16_swap_b32 v146, v147
    v_min_f32 v15, v146, v147
    v_sub_f32 v168, v196, v13
    v_sub_f32 v172, v15, v196
    v_sub_f32 v169, v197, v13
    v_sub_f32 v173, v15, v197
    v_sub_f32 v170, v198, v13
    v_sub_f32 v174, v15, v198
    v_sub_f32 v171, v199, v13
    v_sub_f32 v175, v15, v199
    v_exp_f32 v168, v168
    v_exp_f32 v169, v169
    v_exp_f32 v170, v170
    v_exp_f32 v171, v171
    v_exp_f32 v172, v172
    v_exp_f32 v173, v173
    v_exp_f32 v174, v174
    v_exp_f32 v175, v175
    v_max3_f32 v13, v200, v201, v202
    v_max_f32 v13, v13, v203
    v_mov_b32 v146, v13
    v_mov_b32 v147, v13
    s_nop 1
    v_permlane32_swap_b32 v146, v147
    v_max_f32 v13, v146, v147
    v_mov_b32 v146, v13
    v_mov_b32 v147, v13
    s_nop 1
    v_permlane16_swap_b32 v146, v147
    v_max_f32 v13, v146, v147
    v_min3_f32 v15, v200, v201, v202
    v_min_f32 v15, v15, v203
    v_mov_b32 v146, v15
    v_mov_b32 v147, v15
    s_nop 1
    v_permlane32_swap_b32 v146, v147
    v_min_f32 v15, v146, v147
    v_mov_b32 v146, v15
    v_mov_b32 v147, v15
    s_nop 1
    v_permlane16_swap_b32 v146, v147
    v_min_f32 v15, v146, v147
    v_sub_f32 v176, v200, v13
    v_sub_f32 v180, v15, v200
    v_sub_f32 v177, v201, v13
    v_sub_f32 v181, v15, v201
    v_sub_f32 v178, v202, v13
    v_sub_f32 v182, v15, v202
    v_sub_f32 v179, v203, v13
    v_sub_f32 v183, v15, v203
    v_exp_f32 v176, v176
    v_exp_f32 v177, v177
    v_exp_f32 v178, v178
    v_exp_f32 v179, v179
    v_exp_f32 v180, v180
    v_exp_f32 v181, v181
    v_exp_f32 v182, v182
    v_exp_f32 v183, v183
    v_max3_f32 v13, v204, v205, v206
    v_max_f32 v13, v13, v207
    v_mov_b32 v146, v13
    v_mov_b32 v147, v13
    s_nop 1
    v_permlane32_swap_b32 v146, v147
    v_max_f32 v13, v146, v147
    v_mov_b32 v146, v13
    v_mov_b32 v147, v13
    s_nop 1
    v_permlane16_swap_b32 v146, v147
    v_max_f32 v13, v146, v147
    v_min3_f32 v15, v204, v205, v206
    v_min_f32 v15, v15, v207
    v_mov_b32 v146, v15
    v_mov_b32 v147, v15
    s_nop 1
    v_permlane32_swap_b32 v146, v147
    v_min_f32 v15, v146, v147
    v_mov_b32 v146, v15
    v_mov_b32 v147, v15
    s_nop 1
    v_permlane16_swap_b32 v146, v147
    v_min_f32 v15, v146, v147
    v_sub_f32 v184, v204, v13
    v_sub_f32 v188, v15, v204
    v_sub_f32 v185, v205, v13
    v_sub_f32 v189, v15, v205
    v_sub_f32 v186, v206, v13
    v_sub_f32 v190, v15, v206
    v_sub_f32 v187, v207, v13
    v_sub_f32 v191, v15, v207
    v_exp_f32 v184, v184
    v_exp_f32 v185, v185
    v_exp_f32 v186, v186
    v_exp_f32 v187, v187
    v_exp_f32 v188, v188
    v_exp_f32 v189, v189
    v_exp_f32 v190, v190
    v_exp_f32 v191, v191
    s_nop 1
    s_branch L_phj10
L_fs11:
    s_mov_b32 s55, 20000
L_sp13:
    buffer_load_dword v111, v121, s[4:7], 0 offen sc1
    s_waitcnt vmcnt(0)
    v_cmp_gt_u32 vcc, 1, v111
    s_cmp_eq_u64 vcc, 0
    s_cbranch_scc1 L_sd14
    s_sub_u32 s55, s55, 1
    s_cmp_eq_u32 s55, 0
    s_cbranch_scc1 L_sd14
    s_sleep 1
    s_branch L_sp13
L_sd14:
    s_branch L_fb12
L_qs16:
    s_mov_b32 s55, 20000
L_qp18:
    s_mov_b64 exec, 0x3f
    buffer_load_dword v4, v127, s[20:23], 0 offen sc1
    s_mov_b64 exec, -1
    s_waitcnt vmcnt(0)
    v_cmp_gt_u32 vcc, 1, v4
    s_and_b32 s56, vcc_lo, 0x3f
    s_cbranch_scc0 L_qb17
    s_sub_u32 s55, s55, 1
    s_cmp_lg_u32 s55, 0
    s_cbranch_scc1 L_qp18
    s_branch L_qb17
L_qs19:
    s_mov_b32 s55, 20000
L_qp21:
    s_mov_b64 exec, 0xf00
    buffer_load_dword v11, v127, s[20:23], 0 offen sc1
    s_mov_b64 exec, -1
    s_waitcnt vmcnt(0)
    v_cmp_gt_u32 vcc, 1, v11
    s_and_b32 s56, vcc_lo, 0xf00
    s_cbranch_scc0 L_qb20
    s_sub_u32 s55, s55, 1
    s_cmp_lg_u32 s55, 0
    s_cbranch_scc1 L_qp21
    s_branch L_qb20
L_phs24:
    s_nop 1
    v_max3_f32 v13, v48, v49, v50
    v_max_f32 v13, v13, v51
    v_mov_b32 v162, v13
    v_mov_b32 v163, v13
    s_nop 1
    v_permlane32_swap_b32 v162, v163
    v_max_f32 v13, v162, v163
    v_mov_b32 v162, v13
    v_mov_b32 v163, v13
    s_nop 1
    v_permlane16_swap_b32 v162, v163
    v_max_f32 v13, v162, v163
    v_min3_f32 v15, v48, v49, v50
    v_min_f32 v15, v15, v51
    v_mov_b32 v162, v15
    v_mov_b32 v163, v15
    s_nop 1
    v_permlane32_swap_b32 v162, v163
    v_min_f32 v15, v162, v163
    v_mov_b32 v162, v15
    v_mov_b32 v163, v15
    s_nop 1
    v_permlane16_swap_b32 v162, v163
    v_min_f32 v15, v162, v163
    v_sub_f32 v128, v48, v13
    v_sub_f32 v132, v15, v48
    v_sub_f32 v129, v49, v13
    v_sub_f32 v133, v15, v49
    v_sub_f32 v130, v50, v13
    v_sub_f32 v134, v15, v50
    v_sub_f32 v131, v51, v13
    v_sub_f32 v135, v15, v51
    v_exp_f32 v128, v128
    v_exp_f32 v129, v129
    v_exp_f32 v130, v130
    v_exp_f32 v131, v131
    v_exp_f32 v132, v132
    v_exp_f32 v133, v133
    v_exp_f32 v134, v134
    v_exp_f32 v135, v135
    v_max3_f32 v13, v52, v53, v54
    v_max_f32 v13, v13, v55
    v_mov_b32 v162, v13
    v_mov_b32 v163, v13
    s_nop 1
    v_permlane32_swap_b32 v162, v163
    v_max_f32 v13, v162, v163
    v_mov_b32 v162, v13
    v_mov_b32 v163, v13
    s_nop 1
    v_permlane16_swap_b32 v162, v163
    v_max_f32 v13, v162, v163
    v_min3_f32 v15, v52, v53, v54
    v_min_f32 v15, v15, v55
    v_mov_b32 v162, v15
    v_mov_b32 v163, v15
    s_nop 1
    v_permlane32_swap_b32 v162, v163
    v_min_f32 v15, v162, v163
    v_mov_b32 v162, v15
    v_mov_b32 v163, v15
    s_nop 1
    v_permlane16_swap_b32 v162, v163
    v_min_f32 v15, v162, v163
    v_sub_f32 v136, v52, v13
    v_sub_f32 v140, v15, v52
    v_sub_f32 v137, v53, v13
    v_sub_f32 v141, v15, v53
    v_sub_f32 v138, v54, v13
    v_sub_f32 v142, v15, v54
    v_sub_f32 v139, v55, v13
    v_sub_f32 v143, v15, v55
    v_exp_f32 v136, v136
    v_exp_f32 v137, v137
    v_exp_f32 v138, v138
    v_exp_f32 v139, v139
    v_exp_f32 v140, v140
    v_exp_f32 v141, v141
    v_exp_f32 v142, v142
    v_exp_f32 v143, v143
    v_max3_f32 v13, v56, v57, v58
    v_max_f32 v13, v13, v59
    v_mov_b32 v162, v13
    v_mov_b32 v163, v13
    s_nop 1
    v_permlane32_swap_b32 v162, v163
    v_max_f32 v13, v162, v163
    v_mov_b32 v162, v13
    v_mov_b32 v163, v13
    s_nop 1
    v_permlane16_swap_b32 v162, v163
    v_max_f32 v13, v162, v163
    v_min3_f32 v15, v56, v57, v58
    v_min_f32 v15, v15, v59
    v_mov_b32 v162, v15
    v_mov_b32 v163, v15
    s_nop 1
    v_permlane32_swap_b32 v162, v163
    v_min_f32 v15, v162, v163
    v_mov_b32 v162, v15
    v_mov_b32 v163, v15
    s_nop 1
    v_permlane16_swap_b32 v162, v163
    v_min_f32 v15, v162, v163
    v_sub_f32 v144, v56, v13
    v_sub_f32 v148, v15, v56
    v_sub_f32 v145, v57, v13
    v_sub_f32 v149, v15, v57
    v_sub_f32 v146, v58, v13
    v_sub_f32 v150, v15, v58
    v_sub_f32 v147, v59, v13
    v_sub_f32 v151, v15, v59
    v_exp_f32 v144, v144
    v_exp_f32 v145, v145
    v_exp_f32 v146, v146
    v_exp_f32 v147, v147
    v_exp_f32 v148, v148
    v_exp_f32 v149, v149
    v_exp_f32 v150, v150
    v_exp_f32 v151, v151
    v_max3_f32 v13, v60, v61, v62
    v_max_f32 v13, v13, v63
    v_mov_b32 v162, v13
    v_mov_b32 v163, v13
    s_nop 1
    v_permlane32_swap_b32 v162, v163
    v_max_f32 v13, v162, v163
    v_mov_b32 v162, v13
    v_mov_b32 v163, v13
    s_nop 1
    v_permlane16_swap_b32 v162, v163
    v_max_f32 v13, v162, v163
    v_min3_f32 v15, v60, v61, v62
    v_min_f32 v15, v15, v63
    v_mov_b32 v162, v15
    v_mov_b32 v163, v15
    s_nop 1
    v_permlane32_swap_b32 v162, v163
    v_min_f32 v15, v162, v163
    v_mov_b32 v162, v15
    v_mov_b32 v163, v15
    s_nop 1
    v_permlane16_swap_b32 v162, v163
    v_min_f32 v15, v162, v163
    v_sub_f32 v152, v60, v13
    v_sub_f32 v156, v15, v60
    v_sub_f32 v153, v61, v13
    v_sub_f32 v157, v15, v61
    v_sub_f32 v154, v62, v13
    v_sub_f32 v158, v15, v62
    v_sub_f32 v155, v63, v13
    v_sub_f32 v159, v15, v63
    v_exp_f32 v152, v152
    v_exp_f32 v153, v153
    v_exp_f32 v154, v154
    v_exp_f32 v155, v155
    v_exp_f32 v156, v156
    v_exp_f32 v157, v157
    v_exp_f32 v158, v158
    v_exp_f32 v159, v159
    s_nop 1
    s_branch L_phj25
L_fs26:
    s_mov_b32 s55, 20000
L_sp28:
    buffer_load_dword v111, v121, s[4:7], 0 offen sc1
    s_waitcnt vmcnt(0)
    v_cmp_gt_u32 vcc, 1, v111
    s_cmp_eq_u64 vcc, 0
    s_cbranch_scc1 L_sd29
    s_sub_u32 s55, s55, 1
    s_cmp_eq_u32 s55, 0
    s_cbranch_scc1 L_sd29
    s_sleep 1
    s_branch L_sp28
L_sd29:
    s_branch L_fb27
L_qs31:
    s_mov_b32 s55, 20000
L_qp33:
    s_mov_b64 exec, 0x3f
    buffer_load_dword v4, v127, s[20:23], 0 offen sc1
    s_mov_b64 exec, -1
    s_waitcnt vmcnt(0)
    v_cmp_gt_u32 vcc, 1, v4
    s_and_b32 s56, vcc_lo, 0x3f
    s_cbranch_scc0 L_qb32
    s_sub_u32 s55, s55, 1
    s_cmp_lg_u32 s55, 0
    s_cbranch_scc1 L_qp33
    s_branch L_qb32
L_qs34:
    s_mov_b32 s55, 20000
L_qp36:
    s_mov_b64 exec, 0xf00
    buffer_load_dword v11, v127, s[20:23], 0 offen sc1
    s_mov_b64 exec, -1
    s_waitcnt vmcnt(0)
    v_cmp_gt_u32 vcc, 1, v11
    s_and_b32 s56, vcc_lo, 0xf00
    s_cbranch_scc0 L_qb35
    s_sub_u32 s55, s55, 1
    s_cmp_lg_u32 s55, 0
    s_cbranch_scc1 L_qp36
    s_branch L_qb35
L_phs39:
    s_nop 1
    v_max3_f32 v13, v192, v193, v194
    v_max_f32 v13, v13, v195
    v_mov_b32 v146, v13
    v_mov_b32 v147, v13
    s_nop 1
    v_permlane32_swap_b32 v146, v147
    v_max_f32 v13, v146, v147
    v_mov_b32 v146, v13
    v_mov_b32 v147, v13
    s_nop 1
    v_permlane16_swap_b32 v146, v147
    v_max_f32 v13, v146, v147
    v_min3_f32 v15, v192, v193, v194
    v_min_f32 v15, v15, v195
    v_mov_b32 v146, v15
    v_mov_b32 v147, v15
    s_nop 1
    v_permlane32_swap_b32 v146, v147
    v_min_f32 v15, v146, v147
    v_mov_b32 v146, v15
    v_mov_b32 v147, v15
    s_nop 1
    v_permlane16_swap_b32 v146, v147
    v_min_f32 v15, v146, v147
    v_sub_f32 v160, v192, v13
    v_sub_f32 v164, v15, v192
    v_sub_f32 v161, v193, v13
    v_sub_f32 v165, v15, v193
    v_sub_f32 v162, v194, v13
    v_sub_f32 v166, v15, v194
    v_sub_f32 v163, v195, v13
    v_sub_f32 v167, v15, v195
    v_exp_f32 v160, v160
    v_exp_f32 v161, v161
    v_exp_f32 v162, v162
    v_exp_f32 v163, v163
    v_exp_f32 v164, v164
    v_exp_f32 v165, v165
    v_exp_f32 v166, v166
    v_exp_f32 v167, v167
    v_max3_f32 v13, v196, v197, v198
    v_max_f32 v13, v13, v199
    v_mov_b32 v146, v13
    v_mov_b32 v147, v13
    s_nop 1
    v_permlane32_swap_b32 v146, v147
    v_max_f32 v13, v146, v147
    v_mov_b32 v146, v13
    v_mov_b32 v147, v13
    s_nop 1
    v_permlane16_swap_b32 v146, v147
    v_max_f32 v13, v146, v147
    v_min3_f32 v15, v196, v197, v198
    v_min_f32 v15, v15, v199
    v_mov_b32 v146, v15
    v_mov_b32 v147, v15
    s_nop 1
    v_permlane32_swap_b32 v146, v147
    v_min_f32 v15, v146, v147
    v_mov_b32 v146, v15
    v_mov_b32 v147, v15
    s_nop 1
    v_permlane16_swap_b32 v146, v147
    v_min_f32 v15, v146, v147
    v_sub_f32 v168, v196, v13
    v_sub_f32 v172, v15, v196
    v_sub_f32 v169, v197, v13
    v_sub_f32 v173, v15, v197
    v_sub_f32 v170, v198, v13
    v_sub_f32 v174, v15, v198
    v_sub_f32 v171, v199, v13
    v_sub_f32 v175, v15, v199
    v_exp_f32 v168, v168
    v_exp_f32 v169, v169
    v_exp_f32 v170, v170
    v_exp_f32 v171, v171
    v_exp_f32 v172, v172
    v_exp_f32 v173, v173
    v_exp_f32 v174, v174
    v_exp_f32 v175, v175
    v_max3_f32 v13, v200, v201, v202
    v_max_f32 v13, v13, v203
    v_mov_b32 v146, v13
    v_mov_b32 v147, v13
    s_nop 1
    v_permlane32_swap_b32 v146, v147
    v_max_f32 v13, v146, v147
    v_mov_b32 v146, v13
    v_mov_b32 v147, v13
    s_nop 1
    v_permlane16_swap_b32 v146, v147
    v_max_f32 v13, v146, v147
    v_min3_f32 v15, v200, v201, v202
    v_min_f32 v15, v15, v203
    v_mov_b32 v146, v15
    v_mov_b32 v147, v15
    s_nop 1
    v_permlane32_swap_b32 v146, v147
    v_min_f32 v15, v146, v147
    v_mov_b32 v146, v15
    v_mov_b32 v147, v15
    s_nop 1
    v_permlane16_swap_b32 v146, v147
    v_min_f32 v15, v146, v147
    v_sub_f32 v176, v200, v13
    v_sub_f32 v180, v15, v200
    v_sub_f32 v177, v201, v13
    v_sub_f32 v181, v15, v201
    v_sub_f32 v178, v202, v13
    v_sub_f32 v182, v15, v202
    v_sub_f32 v179, v203, v13
    v_sub_f32 v183, v15, v203
    v_exp_f32 v176, v176
    v_exp_f32 v177, v177
    v_exp_f32 v178, v178
    v_exp_f32 v179, v179
    v_exp_f32 v180, v180
    v_exp_f32 v181, v181
    v_exp_f32 v182, v182
    v_exp_f32 v183, v183
    v_max3_f32 v13, v204, v205, v206
    v_max_f32 v13, v13, v207
    v_mov_b32 v146, v13
    v_mov_b32 v147, v13
    s_nop 1
    v_permlane32_swap_b32 v146, v147
    v_max_f32 v13, v146, v147
    v_mov_b32 v146, v13
    v_mov_b32 v147, v13
    s_nop 1
    v_permlane16_swap_b32 v146, v147
    v_max_f32 v13, v146, v147
    v_min3_f32 v15, v204, v205, v206
    v_min_f32 v15, v15, v207
    v_mov_b32 v146, v15
    v_mov_b32 v147, v15
    s_nop 1
    v_permlane32_swap_b32 v146, v147
    v_min_f32 v15, v146, v147
    v_mov_b32 v146, v15
    v_mov_b32 v147, v15
    s_nop 1
    v_permlane16_swap_b32 v146, v147
    v_min_f32 v15, v146, v147
    v_sub_f32 v184, v204, v13
    v_sub_f32 v188, v15, v204
    v_sub_f32 v185, v205, v13
    v_sub_f32 v189, v15, v205
    v_sub_f32 v186, v206, v13
    v_sub_f32 v190, v15, v206
    v_sub_f32 v187, v207, v13
    v_sub_f32 v191, v15, v207
    v_exp_f32 v184, v184
    v_exp_f32 v185, v185
    v_exp_f32 v186, v186
    v_exp_f32 v187, v187
    v_exp_f32 v188, v188
    v_exp_f32 v189, v189
    v_exp_f32 v190, v190
    v_exp_f32 v191, v191
    s_nop 1
    s_branch L_phj40
L_fs41:
    s_mov_b32 s55, 20000
L_sp43:
    buffer_load_dword v111, v121, s[4:7], 0 offen sc1
    s_waitcnt vmcnt(0)
    v_cmp_gt_u32 vcc, 1, v111
    s_cmp_eq_u64 vcc, 0
    s_cbranch_scc1 L_sd44
    s_sub_u32 s55, s55, 1
    s_cmp_eq_u32 s55, 0
    s_cbranch_scc1 L_sd44
    s_sleep 1
    s_branch L_sp43
L_sd44:
    s_branch L_fb42
L_qs45:
    s_mov_b32 s55, 20000
L_qp47:
    s_mov_b64 exec, 0x3f
    buffer_load_dword v4, v127, s[20:23], 0 offen sc1
    s_mov_b64 exec, -1
    s_waitcnt vmcnt(0)
    v_cmp_gt_u32 vcc, 1, v4
    s_and_b32 s56, vcc_lo, 0x3f
    s_cbranch_scc0 L_qb46
    s_sub_u32 s55, s55, 1
    s_cmp_lg_u32 s55, 0
    s_cbranch_scc1 L_qp47
    s_branch L_qb46
L_qs48:
    s_mov_b32 s55, 20000
L_qp50:
    s_mov_b64 exec, 0xf00
    buffer_load_dword v11, v127, s[20:23], 0 offen sc1
    s_mov_b64 exec, -1
    s_waitcnt vmcnt(0)
    v_cmp_gt_u32 vcc, 1, v11
    s_and_b32 s56, vcc_lo, 0xf00
    s_cbranch_scc0 L_qb49
    s_sub_u32 s55, s55, 1
    s_cmp_lg_u32 s55, 0
    s_cbranch_scc1 L_qp50
    s_branch L_qb49
L_fallback:
    s_lshl_b32 s50, s39, 16
    s_lshl_b32 s35, s33, 10
    s_add_u32 s51, s50, 4192256
    s_sub_u32 s51, s51, s35
    s_add_u32 s50, s50, 2097152
    s_mov_b32 s54, s50
    v_mov_b32 v13, 0xff800000
    s_mov_b32 s55, 64
L_fb1:
    buffer_load_dwordx4 v[96:99], v0, s[20:23], s54 offen sc1
    s_add_u32 s54, s54, 1024
    s_waitcnt vmcnt(0)
    v_mfma_f32_32x32x16_bf16 v[64:79], v[96:99], v[6:9], 0
    s_nop 11
    v_max3_f32 v13, v13, v64, v65
    v_max3_f32 v13, v13, v66, v67
    v_max3_f32 v13, v13, v68, v69
    v_max3_f32 v13, v13, v70, v71
    v_max3_f32 v13, v13, v72, v73
    v_max3_f32 v13, v13, v74, v75
    v_max3_f32 v13, v13, v76, v77
    v_max3_f32 v13, v13, v78, v79
    s_sub_u32 s55, s55, 1
    s_cmp_lg_u32 s55, 0
    s_cbranch_scc1 L_fb1
    v_mov_b32 v15, v13
    v_mov_b32 v12, v13
    s_nop 1
    v_permlane32_swap_b32 v15, v12
    v_max_f32 v13, v15, v12
    v_mov_b32 v80, 0
    v_mov_b32 v81, 0
    v_mov_b32 v82, 0
    v_mov_b32 v83, 0
    v_mov_b32 v84, 0
    v_mov_b32 v85, 0
    v_mov_b32 v86, 0
    v_mov_b32 v87, 0
    v_mov_b32 v88, 0
    v_mov_b32 v89, 0
    v_mov_b32 v90, 0
    v_mov_b32 v91, 0
    v_mov_b32 v92, 0
    v_mov_b32 v93, 0
    v_mov_b32 v94, 0
    v_mov_b32 v95, 0
    s_mov_b32 s55, 64
L_fb2:
    buffer_load_dwordx4 v[96:99], v0, s[20:23], s50 offen sc1
    s_mov_b64 exec, s[60:61]
    buffer_load_dwordx4 v[100:103], v113, s[20:23], s51 offen sc1
    buffer_load_dwordx4 v[108:111], v113, s[20:23], s51 offen offset:256 sc1
    s_mov_b64 exec, -1
    s_add_u32 s50, s50, 1024
    s_add_u32 s51, s51, 1024
    s_waitcnt vmcnt(0)
    v_mfma_f32_32x32x16_bf16 v[64:79], v[96:99], v[6:9], 0
    s_nop 11
    v_sub_f32 v64, v64, v13
    v_sub_f32 v65, v65, v13
    v_sub_f32 v66, v66, v13
    v_sub_f32 v67, v67, v13
    v_sub_f32 v68, v68, v13
    v_sub_f32 v69, v69, v13
    v_sub_f32 v70, v70, v13
    v_sub_f32 v71, v71, v13
    v_sub_f32 v72, v72, v13
    v_sub_f32 v73, v73, v13
    v_sub_f32 v74, v74, v13
    v_sub_f32 v75, v75, v13
    v_sub_f32 v76, v76, v13
    v_sub_f32 v77, v77, v13
    v_sub_f32 v78, v78, v13
    v_sub_f32 v79, v79, v13
    v_exp_f32 v64, v64
    v_exp_f32 v65, v65
    v_exp_f32 v66, v66
    v_exp_f32 v67, v67
    v_exp_f32 v68, v68
    v_exp_f32 v69, v69
    v_exp_f32 v70, v70
    v_exp_f32 v71, v71
    v_exp_f32 v72, v72
    v_exp_f32 v73, v73
    v_exp_f32 v74, v74
    v_exp_f32 v75, v75
    v_exp_f32 v76, v76
    v_exp_f32 v77, v77
    v_exp_f32 v78, v78
    v_exp_f32 v79, v79
    v_smfmac_f32_32x32x32_bf16 v[80:95], v[100:103], v[64:71], v10
    s_nop 0
    v_smfmac_f32_32x32x32_bf16 v[80:95], v[108:111], v[72:79], v10
    s_nop 7
    s_sub_u32 s55, s55, 1
    s_cmp_lg_u32 s55, 0
    s_cbranch_scc1 L_fb2
    s_nop 0
    v_rcp_f32 v12, v88
    s_nop 1
    s_branch L_fin
.section .rodata,"a"
.p2align 6
.amdhsa_kernel gated_mix__softmax_full_mha__linear_kernel_hedgehog__prompt_kernel
  .amdhsa_next_free_vgpr 256
  .amdhsa_next_free_sgpr 102
  .amdhsa_accum_offset 256
  .amdhsa_group_segment_fixed_size 0
  .amdhsa_kernarg_size 88
  .amdhsa_user_sgpr_count 2
  .amdhsa_user_sgpr_kernarg_segment_ptr 1
  .amdhsa_system_sgpr_workgroup_id_x 1
.end_amdhsa_kernel
```
